```python
import torch

def _softmax(x, axis=-1):
    return torch.softmax(x, dim=axis)
def _gelu(x):
    return torch.nn.functional.gelu(x, approximate="tanh")
def _silu(x):
    return torch.nn.functional.silu(x)
def _sigmoid(x):
    return torch.sigmoid(x)
def _layernorm(x, axis=-1, eps=1e-5):
    m = x.mean(dim=axis, keepdim=True)
    v = x.var(dim=axis, keepdim=True, unbiased=False)
    return (x - m) / torch.sqrt(v + eps)
def _scatter_add(tgt, idx, src, axis=0):
    return tgt.clone().index_add_(axis, idx, src)
def _segment_sum(src, seg, n):
    out = torch.zeros((n,) + src.shape[1:], dtype=src.dtype)
    return out.index_add_(0, seg, src)
def _pad(x, pw):
    flat = tuple(v for pair in reversed(pw) for v in pair)
    return torch.nn.functional.pad(x, flat)

kernel_name = 'sequential_preLN__ssm_conv_h3__dense_activation_silu__prompt'

def setup_inputs():

    _w = (lambda a: (lambda t: t.to(torch.bfloat16) if t.is_floating_point() else t)(torch.as_tensor(a)))
    def _A_setup():
        B, S, D = 1, 2048, 512
        ks = 4
        return {
            "q": _w((lambda *s: torch.randn(*s, dtype=torch.bfloat16) * 0.05)(B, S, D)),
            "k": _w((lambda *s: torch.randn(*s, dtype=torch.bfloat16) * 0.2)(B, S, D)),
            "v": _w((lambda *s: torch.randn(*s, dtype=torch.bfloat16) * 0.2)(B, S, D)),
            "shift_k": _w((lambda *s: torch.randn(*s, dtype=torch.bfloat16) * 0.2)(D, ks) * 0.5),
            "ssm_k": _w((lambda *s: torch.randn(*s, dtype=torch.bfloat16) * 0.4)(D, S) * (1.0 / S ** 0.5)),
            "ssm_D": _w((lambda *s: torch.randn(*s, dtype=torch.bfloat16) * 0.2)(D)),
        }
    _A_in = _A_setup()

    def _B_setup():
        B, S, D, F = 1, 2048, 512, 1792
        return {
            "x": _w((lambda *s: torch.randn(*s, dtype=torch.bfloat16) * 0.05)(B, S, D)),
            "w1": _w((lambda *s: torch.randn(*s, dtype=torch.bfloat16) * 0.8)(D, F) * (D ** -0.5)),
            "w2": _w((lambda *s: torch.randn(*s, dtype=torch.bfloat16) * 0.1)(F, D) * (F ** -0.5)),
        }
    _B_in = _B_setup()

    return {
        "A_q": _A_in["q"],
        "A_k": _A_in["k"],
        "A_v": _A_in["v"],
        "A_shift_k": _A_in["shift_k"],
        "A_ssm_k": _A_in["ssm_k"],
        "A_ssm_D": _A_in["ssm_D"],
        "B_x": _B_in["x"],
        "B_w1": _B_in["w1"],
        "B_w2": _B_in["w2"],
    }

def reference(A_q, A_k, A_v, A_shift_k, A_ssm_k, A_ssm_D, B_x, B_w1, B_w2):
    def _A_ref(q, k, v, shift_k, ssm_k, ssm_D):
        B, S, D = q.shape
        ks = shift_k.shape[-1]
        k_pad = _pad(k, ((0, 0), (ks - 1, 0), (0, 0)))
        k_shift = torch.zeros_like(k)
        for t in range(ks):
            k_shift = k_shift + k_pad[:, t:t + S, :] * shift_k[:, ks - 1 - t][None, None, :]
        kv = k_shift * v
        L = 2 * S
        kv_pad = _pad(kv, ((0, 0), (0, S), (0, 0)))
        kf_pad = _pad(ssm_k, ((0, 0), (0, S)))
        kv_f = (lambda x, axes=(-2,-1): torch.fft.rfft2(x.float(), dim=axes))(kv_pad[:, None, :, :], axes=(1, 2))
        kf_f = (lambda x, axes=(-2,-1): torch.fft.rfft2(x.float(), dim=axes))(kf_pad[:, None, :], axes=(1, 2))
        kf_f = (lambda x, *d: x.permute(*d))(kf_f, 1, 2, 0)
        y_f = kv_f * kf_f[None, :, :, :]
        y = (lambda x, s, axes=(-2,-1): torch.fft.irfft2(x, s=s, dim=axes).to(torch.bfloat16))(y_f, (1, L), axes=(1, 2))[:, 0, :S, :]
        y = y + kv * ssm_D[None, None, :]
        return q * y

    def _B_ref(x, w1, w2):
        h = torch.einsum("bsd,df->bsf", x, w1)
        h = _silu(h)
        out = torch.einsum("bsf,fd->bsd", h, w2)
        return out

    x = A_q
    h = x + _A_ref(_layernorm(x, axis=-1), A_k, A_v, A_shift_k, A_ssm_k, A_ssm_D)
    h2 = h + _B_ref(_layernorm(h, axis=-1), B_w1, B_w2)
    return h2
```

```asm
; @launch grid=(256,1,1) block=(512,1,1) lds=163840
.amdgcn_target "amdgcn-amd-amdhsa--gfx950"
.text
.globl sequential_preLN__ssm_conv_h3__dense_activation_silu__prompt_kernel
.p2align 8
.type sequential_preLN__ssm_conv_h3__dense_activation_silu__prompt_kernel,@function
sequential_preLN__ssm_conv_h3__dense_activation_silu__prompt_kernel:
    s_cmp_ge_u32 s2, 256
    s_cbranch_scc1 L_end
    s_load_dwordx16 s[4:19], s[0:1], 0
    s_load_dwordx8 s[20:27], s[0:1], 64
    v_lshrrev_b32 v4, 6, v0
    v_and_b32 v1, 63, v0
    v_readfirstlane_b32 s28, v4
    v_and_b32 v2, 15, v0
    v_bfe_u32 v3, v0, 4, 2
    v_lshlrev_b32 v5, 4, v1
    v_lshlrev_b32 v14, 7, v1
    s_and_b32 s29, s2, 7
    s_lshr_b32 s30, s2, 3
    v_and_b32 v10, 31, v0
    v_bfe_u32 v11, v0, 5, 3
    s_lshl_b32 s72, s30, 16
    s_lshl_b32 s73, s29, 7
    s_add_u32 s72, s72, s73
    v_lshlrev_b32 v12, 13, v11
    v_lshl_add_u32 v12, v10, 2, v12
    v_add_u32 v12, s72, v12
    s_movk_i32 s74, 4096
    s_lshr_b32 s78, s28, 2
    s_and_b32 s79, s28, 3
    s_mul_i32 s80, s78, 16640
    s_add_u32 s80, s80, 123904
    s_mul_i32 s82, s78, 4608
    s_add_u32 s82, s82, 114688
    s_lshl_b32 s83, s29, 5
    s_add_u32 s83, s83, s30
    s_lshl_b32 s81, s83, 1
    s_add_u32 s81, s81, s78
    s_lshl_b32 s81, s81, 12
    s_lshl_b32 s72, s79, 10
    s_add_u32 s81, s81, s72
    s_cmp_ge_u32 s28, 4
    s_cbranch_scc1 L_aux
    v_subrev_u32 v13, 3072, v12
    v_mov_b32 v4, 2146435072
    v_cmp_gt_i32 vcc, 0, v13
    s_lshl_b32 s75, s29, 9
    v_lshlrev_b32 v24, 4, v10
    v_cndmask_b32 v13, v13, v4, vcc
    s_waitcnt lgkmcnt(0)
    s_mov_b32 s36, s6
    s_mov_b32 s37, s7
    s_mov_b32 s38, 2097152
    s_mov_b32 s39, 0x00020000
    s_mov_b32 s64, s24
    s_mov_b32 s65, s25
    s_mov_b32 s66, 256
    s_mov_b32 s67, 0x00020000
    s_or_b32 s72, s2, s28
    s_cmp_lg_u32 s72, 0
    s_cbranch_scc1 Lnotag_1
    s_memrealtime s[72:73]
    s_waitcnt lgkmcnt(0)
    s_or_b32 s72, s72, 1
    v_mov_b32 v6, s72
    v_mov_b32 v7, s73
    v_mov_b32 v4, 0
    s_mov_b64 exec, 1
    buffer_store_dwordx2 v[6:7], v4, s[64:67], 0 offen sc1
    s_mov_b64 exec, -1
Lnotag_1:
    buffer_load_dword v48, v13, s[36:39], 0 offen offset:0 nt
    buffer_load_dword v49, v13, s[36:39], 0 offen offset:1024 nt
    buffer_load_dword v50, v13, s[36:39], 0 offen offset:2048 nt
    buffer_load_dword v51, v12, s[36:39], 0 offen offset:0 nt
    buffer_load_dword v52, v12, s[36:39], 0 offen offset:1024 nt
    buffer_load_dword v53, v12, s[36:39], 0 offen offset:2048 nt
    buffer_load_dword v54, v12, s[36:39], 0 offen offset:3072 nt
    buffer_load_dword v55, v12, s[36:39], s74 offen offset:0 nt
    buffer_load_dword v56, v12, s[36:39], s74 offen offset:1024 nt
    buffer_load_dword v57, v12, s[36:39], s74 offen offset:2048 nt
    buffer_load_dword v58, v12, s[36:39], s74 offen offset:3072 nt
    s_mov_b32 s44, s10
    s_mov_b32 s45, s11
    s_mov_b32 s46, 4096
    s_mov_b32 s47, 0x00020000
    buffer_load_dwordx4 v[76:79], v24, s[44:47], s75 offen
    s_mov_b32 s40, s8
    s_mov_b32 s41, s9
    s_mov_b32 s42, 2097152
    s_mov_b32 s43, 0x00020000
    buffer_load_dword v60, v12, s[40:43], 0 offen offset:0 nt
    buffer_load_dword v61, v12, s[40:43], 0 offen offset:1024 nt
    buffer_load_dword v62, v12, s[40:43], 0 offen offset:2048 nt
    buffer_load_dword v63, v12, s[40:43], 0 offen offset:3072 nt
    buffer_load_dword v64, v12, s[40:43], s74 offen offset:0 nt
    buffer_load_dword v65, v12, s[40:43], s74 offen offset:1024 nt
    buffer_load_dword v66, v12, s[40:43], s74 offen offset:2048 nt
    buffer_load_dword v67, v12, s[40:43], s74 offen offset:3072 nt
    s_mov_b32 s48, s12
    s_mov_b32 s49, s13
    s_mov_b32 s50, 2097152
    s_mov_b32 s51, 0x00020000
    s_mov_b32 s68, s26
    s_mov_b32 s69, s27
    s_mov_b32 s70, 268435456
    s_mov_b32 s71, 0x00020000
    buffer_load_dwordx4 v[16:19], v5, s[48:51], s81 offen nt
    buffer_load_dwordx2 v[20:21], v5, s[48:51], s81 offen offset:16 nt
    s_mov_b32 s52, s18
    s_mov_b32 s53, s19
    s_mov_b32 s54, 1835008
    s_mov_b32 s55, 0x00020000
    s_mov_b32 s60, s22
    s_mov_b32 s61, s23
    s_mov_b32 s62, 2097152
    s_mov_b32 s63, 0x00020000
    s_mov_b32 s56, s20
    s_mov_b32 s57, s21
    s_mov_b32 s58, 1835008
    s_mov_b32 s59, 0x00020000
    s_cmp_lg_u32 s79, 0
    s_cbranch_scc1 Lnz_2
    v_mov_b32 v44, 0
    v_mov_b32 v45, 0
    v_mov_b32 v46, 0
    v_mov_b32 v47, 0
    s_mov_b32 exec_hi, 0
    v_add_u32 v43, s82, v5
    ds_write_b128 v43, v[44:47]
    s_mov_b64 exec, 0xff
    v_lshrrev_b32 v42, 1, v1
    v_mul_u32_u24 v42, 4160, v42
    v_and_b32 v4, 1, v1
    v_lshl_add_u32 v42, v4, 4, v42
    v_add_u32 v42, s80, v42
    ds_write_b128 v42, v[44:47]
    v_mov_b32 v42, 157184
    ds_write_b64 v42, v[44:45]
    s_mov_b64 exec, -1
Lnz_2:
    v_and_b32 v4, 7, v10
    v_xor_b32 v4, v4, v11
    v_lshlrev_b32 v22, 8, v10
    v_lshl_add_u32 v22, v4, 4, v22
    v_add_u32 v22, 28672, v22
    v_lshrrev_b32 v23, 3, v1
    v_lshrrev_b32 v4, 4, v1
    v_and_b32 v13, 7, v1
    v_xor_b32 v4, v4, v13
    v_lshlrev_b32 v4, 4, v4
    v_lshl_add_u32 v4, v23, 7, v4
    v_lshlrev_b32 v13, 4, v13
    v_lshl_add_u32 v13, v23, 12, v13
    s_lshl_b32 s72, s28, 11
    s_add_u32 s72, s72, 28672
    v_add_u32 v23, s72, v4
    v_xor_b32 v12, 64, v23
    s_lshl_b32 s72, s29, 18
    s_lshl_b32 s73, s30, 7
    s_add_u32 s90, s72, s73
    s_lshl_b32 s72, s28, 16
    s_add_u32 s90, s90, s72
    s_add_u32 s90, s90, 0
    s_add_u32 s91, s90, 32768
    s_getreg_b32 s95, hwreg(HW_REG_XCC_ID)
    s_and_b32 s95, s95, 0xff
    s_waitcnt vmcnt(10)
    v_mov_b32 v4, 0
    buffer_load_dwordx2 v[6:7], v4, s[64:67], 0 offen sc1
    v_lshlrev_b32 v80, 16, v76
    v_lshlrev_b32 v81, 16, v78
    v_and_b32 v82, 0xffff0000, v76
    v_and_b32 v83, 0xffff0000, v78
    v_lshlrev_b32 v84, 16, v77
    v_lshlrev_b32 v85, 16, v79
    v_and_b32 v86, 0xffff0000, v77
    v_and_b32 v87, 0xffff0000, v79
    v_lshlrev_b32 v88, 16, v48
    v_and_b32 v89, 0xffff0000, v48
    v_lshlrev_b32 v90, 16, v49
    v_and_b32 v91, 0xffff0000, v49
    v_lshlrev_b32 v92, 16, v50
    v_and_b32 v93, 0xffff0000, v50
    v_lshlrev_b32 v94, 16, v51
    v_and_b32 v95, 0xffff0000, v51
    v_lshlrev_b32 v96, 16, v52
    v_and_b32 v97, 0xffff0000, v52
    v_lshlrev_b32 v98, 16, v53
    v_and_b32 v99, 0xffff0000, v53
    v_lshlrev_b32 v100, 16, v54
    v_and_b32 v101, 0xffff0000, v54
    v_lshlrev_b32 v102, 16, v55
    v_and_b32 v103, 0xffff0000, v55
    v_lshlrev_b32 v104, 16, v56
    v_and_b32 v105, 0xffff0000, v56
    v_lshlrev_b32 v106, 16, v57
    v_and_b32 v107, 0xffff0000, v57
    v_lshlrev_b32 v108, 16, v58
    v_and_b32 v109, 0xffff0000, v58
    v_pk_mul_f32 v[112:113], v[88:89], v[86:87]
    v_pk_mul_f32 v[114:115], v[90:91], v[86:87]
    v_pk_mul_f32 v[116:117], v[92:93], v[86:87]
    v_pk_mul_f32 v[118:119], v[94:95], v[86:87]
    v_pk_mul_f32 v[120:121], v[96:97], v[86:87]
    v_pk_mul_f32 v[122:123], v[98:99], v[86:87]
    v_pk_mul_f32 v[124:125], v[100:101], v[86:87]
    v_pk_mul_f32 v[126:127], v[102:103], v[86:87]
    v_pk_fma_f32 v[112:113], v[90:91], v[84:85], v[112:113]
    v_pk_fma_f32 v[114:115], v[92:93], v[84:85], v[114:115]
    v_pk_fma_f32 v[116:117], v[94:95], v[84:85], v[116:117]
    v_pk_fma_f32 v[118:119], v[96:97], v[84:85], v[118:119]
    v_pk_fma_f32 v[120:121], v[98:99], v[84:85], v[120:121]
    v_pk_fma_f32 v[122:123], v[100:101], v[84:85], v[122:123]
    v_pk_fma_f32 v[124:125], v[102:103], v[84:85], v[124:125]
    v_pk_fma_f32 v[126:127], v[104:105], v[84:85], v[126:127]
    v_pk_fma_f32 v[112:113], v[92:93], v[82:83], v[112:113]
    v_pk_fma_f32 v[114:115], v[94:95], v[82:83], v[114:115]
    v_pk_fma_f32 v[116:117], v[96:97], v[82:83], v[116:117]
    v_pk_fma_f32 v[118:119], v[98:99], v[82:83], v[118:119]
    v_pk_fma_f32 v[120:121], v[100:101], v[82:83], v[120:121]
    v_pk_fma_f32 v[122:123], v[102:103], v[82:83], v[122:123]
    v_pk_fma_f32 v[124:125], v[104:105], v[82:83], v[124:125]
    v_pk_fma_f32 v[126:127], v[106:107], v[82:83], v[126:127]
    v_pk_fma_f32 v[112:113], v[94:95], v[80:81], v[112:113]
    v_pk_fma_f32 v[114:115], v[96:97], v[80:81], v[114:115]
    v_pk_fma_f32 v[116:117], v[98:99], v[80:81], v[116:117]
    v_pk_fma_f32 v[118:119], v[100:101], v[80:81], v[118:119]
    v_pk_fma_f32 v[120:121], v[102:103], v[80:81], v[120:121]
    v_pk_fma_f32 v[122:123], v[104:105], v[80:81], v[122:123]
    v_pk_fma_f32 v[124:125], v[106:107], v[80:81], v[124:125]
    v_pk_fma_f32 v[126:127], v[108:109], v[80:81], v[126:127]
    s_waitcnt vmcnt(3)
    v_lshlrev_b32 v88, 16, v60
    v_and_b32 v89, 0xffff0000, v60
    v_lshlrev_b32 v90, 16, v61
    v_and_b32 v91, 0xffff0000, v61
    v_lshlrev_b32 v92, 16, v62
    v_and_b32 v93, 0xffff0000, v62
    v_lshlrev_b32 v94, 16, v63
    v_and_b32 v95, 0xffff0000, v63
    v_lshlrev_b32 v96, 16, v64
    v_and_b32 v97, 0xffff0000, v64
    v_lshlrev_b32 v98, 16, v65
    v_and_b32 v99, 0xffff0000, v65
    v_lshlrev_b32 v100, 16, v66
    v_and_b32 v101, 0xffff0000, v66
    v_lshlrev_b32 v102, 16, v67
    v_and_b32 v103, 0xffff0000, v67
    v_pk_mul_f32 v[112:113], v[112:113], v[88:89]
    v_pk_mul_f32 v[114:115], v[114:115], v[90:91]
    v_pk_mul_f32 v[116:117], v[116:117], v[92:93]
    v_pk_mul_f32 v[118:119], v[118:119], v[94:95]
    v_pk_mul_f32 v[120:121], v[120:121], v[96:97]
    v_pk_mul_f32 v[122:123], v[122:123], v[98:99]
    v_pk_mul_f32 v[124:125], v[124:125], v[100:101]
    v_pk_mul_f32 v[126:127], v[126:127], v[102:103]
    v_cvt_pk_bf16_f32 v128, v126, v124
    v_cvt_pk_bf16_f32 v129, v122, v120
    v_cvt_pk_bf16_f32 v130, v118, v116
    v_cvt_pk_bf16_f32 v131, v114, v112
    v_cvt_pk_bf16_f32 v132, v127, v125
    v_cvt_pk_bf16_f32 v133, v123, v121
    v_cvt_pk_bf16_f32 v134, v119, v117
    v_cvt_pk_bf16_f32 v135, v115, v113
    ds_write_b128 v22, v[128:131]
    ds_write_b128 v22, v[132:135] offset:128
    s_waitcnt lgkmcnt(0)
    s_barrier
    ds_read_b128 v[128:131], v23
    ds_read_b128 v[132:135], v12 offset:1024
    v_mov_b32 v8, s95
    v_mov_b32 v9, 0
    s_waitcnt lgkmcnt(1)
    buffer_store_dwordx4 v[128:131], v13, s[68:71], s90 offen sc1
    s_waitcnt lgkmcnt(0)
    buffer_store_dwordx4 v[132:135], v13, s[68:71], s91 offen sc1
    s_waitcnt vmcnt(3)
    s_lshl_b32 s72, s79, 10
    s_add_u32 s72, s72, s80
    v_add_u32 v40, s72, v5
    ds_write_b128 v40, v[16:19] offset:32
    v_alignbit_b32 v24, v17, v16, 16
    v_alignbit_b32 v25, v18, v17, 16
    v_alignbit_b32 v26, v19, v18, 16
    v_alignbit_b32 v27, v20, v19, 16
    v_mov_b32 v28, v17
    v_mov_b32 v29, v18
    v_mov_b32 v30, v19
    v_mov_b32 v31, v20
    ds_write_b128 v40, v[24:27] offset:4192
    v_mov_b32 v32, v25
    v_mov_b32 v33, v26
    v_mov_b32 v34, v27
    v_alignbit_b32 v35, v21, v20, 16
    ds_write_b128 v40, v[28:31] offset:8352
    ds_write_b128 v40, v[32:35] offset:12512
    s_cmp_lg_u32 s79, 0
    s_cbranch_scc1 Lnofix_3
    s_mov_b64 exec, 1
    v_lshlrev_b32 v37, 16, v16
    v_mov_b32 v36, 0
    v_mov_b32 v38, 0
    v_mov_b32 v39, v16
    v_mov_b32 v42, v37
    v_mov_b32 v43, v24
    ds_write_b64 v40, v[36:37] offset:4184
    ds_write_b64 v40, v[38:39] offset:8344
    ds_write_b64 v40, v[42:43] offset:12504
    s_mov_b64 exec, -1
Lnofix_3:
    s_lshl_b32 s89, s83, 7
    s_add_u32 s89, s89, 20971520
    v_mov_b32 v24, 157188
    v_mov_b32 v25, 1
    s_waitcnt vmcnt(0)
    s_mov_b64 exec, 1
    ds_add_rtn_u32 v25, v24, v25
    s_mov_b64 exec, -1
    s_mov_b32 s72, 40000
Ltag_4:
    v_readfirstlane_b32 s73, v6
    s_cmp_lg_u32 s73, 0
    s_cbranch_scc1 Ltagd_5
    s_sub_u32 s72, s72, 1
    s_cmp_eq_u32 s72, 0
    s_cbranch_scc1 Ltagd_5
    v_mov_b32 v4, 0
    buffer_load_dwordx2 v[6:7], v4, s[64:67], 0 offen sc1
    s_waitcnt vmcnt(0)
    s_branch Ltag_4
Ltagd_5:
    s_waitcnt lgkmcnt(0)
    v_readfirstlane_b32 s72, v25
    s_cmp_lg_u32 s72, 3
    s_cbranch_scc1 Lnf1_6
    v_mov_b32 v4, 0
    s_mov_b64 exec, 1
    buffer_store_dwordx2 v[6:7], v4, s[68:71], s89 offen sc1
    s_mov_b64 exec, -1
Lnf1_6:
    s_cmp_lg_u32 s28, 0
    s_cbranch_scc1 L_bg
    s_lshl_b32 s73, s29, 12
    s_add_u32 s73, s73, 20971520
    s_mov_b32 s72, 40000
    s_mov_b32 exec_hi, 0
Lf1_7:
    buffer_load_dwordx2 v[184:185], v14, s[68:71], s73 offen sc1
    s_waitcnt vmcnt(0)
    v_cmp_ne_u64 vcc, v[184:185], v[6:7]
    s_sub_u32 s72, s72, 1
    s_cmp_eq_u32 s72, 0
    s_cbranch_scc1 Lf1d_8
    s_and_b64 exec, exec, vcc
    s_cbranch_scc1 Lf1_7
Lf1d_8:
    s_mov_b64 exec, -1
    s_lshl_b32 s73, s83, 13
    s_add_u32 s73, s73, 0
    s_mov_b32 m0, 115200
    s_nop 0
    buffer_load_dwordx4 v5, s[68:71], s73 offen offset:0 sc1 lds
    buffer_load_dwordx4 v5, s[68:71], s73 offen offset:1024 sc1 lds
    buffer_load_dwordx4 v5, s[68:71], s73 offen offset:2048 sc1 lds
    buffer_load_dwordx4 v5, s[68:71], s73 offen offset:3072 sc1 lds
    s_add_u32 s73, s73, 4096
    s_mov_b32 m0, 119808
    s_nop 0
    buffer_load_dwordx4 v5, s[68:71], s73 offen offset:0 sc1 lds
    buffer_load_dwordx4 v5, s[68:71], s73 offen offset:1024 sc1 lds
    buffer_load_dwordx4 v5, s[68:71], s73 offen offset:2048 sc1 lds
    buffer_load_dwordx4 v5, s[68:71], s73 offen offset:3072 sc1 lds
    s_waitcnt vmcnt(0)
    s_branch L_p0_join
L_bg:
    s_branch L_p0_join
L_aux:
    v_lshrrev_b32 v24, 3, v1
    v_lshlrev_b32 v24, 10, v24
    v_and_b32 v4, 7, v1
    v_lshl_add_u32 v24, v4, 4, v24
    s_lshl_b32 s72, s2, 13
    s_waitcnt lgkmcnt(0)
    s_mov_b32 s32, s4
    s_mov_b32 s33, s5
    s_mov_b32 s34, 2097152
    s_mov_b32 s35, 0x00020000
    buffer_load_dword v48, v12, s[32:35], 0 offen offset:0 nt
    buffer_load_dword v49, v12, s[32:35], 0 offen offset:1024 nt
    buffer_load_dword v50, v12, s[32:35], 0 offen offset:2048 nt
    buffer_load_dword v51, v12, s[32:35], 0 offen offset:3072 nt
    buffer_load_dword v52, v12, s[32:35], s74 offen offset:0 nt
    buffer_load_dword v53, v12, s[32:35], s74 offen offset:1024 nt
    buffer_load_dword v54, v12, s[32:35], s74 offen offset:2048 nt
    buffer_load_dword v55, v12, s[32:35], s74 offen offset:3072 nt
    s_mov_b32 s48, s12
    s_mov_b32 s49, s13
    s_mov_b32 s50, 2097152
    s_mov_b32 s51, 0x00020000
    buffer_load_dwordx4 v[16:19], v5, s[48:51], s81 offen nt
    buffer_load_dwordx2 v[20:21], v5, s[48:51], s81 offen offset:16 nt
    s_cmp_lg_u32 s28, 4
    s_cbranch_scc1 Lnst_9
    buffer_load_dwordx4 v[64:67], v24, s[32:35], s72 offen offset:0 nt
    buffer_load_dwordx4 v[68:71], v24, s[32:35], s72 offen offset:128 nt
    buffer_load_dwordx4 v[72:75], v24, s[32:35], s72 offen offset:256 nt
    buffer_load_dwordx4 v[76:79], v24, s[32:35], s72 offen offset:384 nt
    buffer_load_dwordx4 v[80:83], v24, s[32:35], s72 offen offset:512 nt
    buffer_load_dwordx4 v[84:87], v24, s[32:35], s72 offen offset:640 nt
    buffer_load_dwordx4 v[88:91], v24, s[32:35], s72 offen offset:768 nt
    buffer_load_dwordx4 v[92:95], v24, s[32:35], s72 offen offset:896 nt
Lnst_9:
    s_mov_b32 s56, s20
    s_mov_b32 s57, s21
    s_mov_b32 s58, 1835008
    s_mov_b32 s59, 0x00020000
    s_mov_b32 s52, s18
    s_mov_b32 s53, s19
    s_mov_b32 s54, 1835008
    s_mov_b32 s55, 0x00020000
    s_mov_b32 s64, s24
    s_mov_b32 s65, s25
    s_mov_b32 s66, 256
    s_mov_b32 s67, 0x00020000
    s_mov_b32 s68, s26
    s_mov_b32 s69, s27
    s_mov_b32 s70, 268435456
    s_mov_b32 s71, 0x00020000
    s_mov_b32 s60, s22
    s_mov_b32 s61, s23
    s_mov_b32 s62, 2097152
    s_mov_b32 s63, 0x00020000
    s_cmp_lg_u32 s79, 0
    s_cbranch_scc1 Lnz_10
    v_mov_b32 v44, 0
    v_mov_b32 v45, 0
    v_mov_b32 v46, 0
    v_mov_b32 v47, 0
    s_mov_b32 exec_hi, 0
    v_add_u32 v43, s82, v5
    ds_write_b128 v43, v[44:47]
    s_mov_b64 exec, 0xff
    v_lshrrev_b32 v42, 1, v1
    v_mul_u32_u24 v42, 4160, v42
    v_and_b32 v4, 1, v1
    v_lshl_add_u32 v42, v4, 4, v42
    v_add_u32 v42, s80, v42
    ds_write_b128 v42, v[44:47]
    v_mov_b32 v42, 157184
    ds_write_b64 v42, v[44:45]
    s_mov_b64 exec, -1
Lnz_10:
    v_and_b32 v4, 7, v10
    v_lshlrev_b32 v13, 1, v11
    v_xor_b32 v4, v4, v13
    v_lshlrev_b32 v22, 8, v10
    v_lshl_add_u32 v22, v4, 4, v22
    v_add_u32 v22, 36864, v22
    v_xor_b32 v12, 16, v22
    v_lshrrev_b32 v23, 4, v1
    v_and_b32 v13, 15, v1
    v_xor_b32 v4, v23, v13
    v_lshlrev_b32 v4, 4, v4
    v_lshl_add_u32 v4, v23, 8, v4
    v_lshlrev_b32 v13, 4, v13
    v_lshl_add_u32 v13, v23, 13, v13
    s_lshl_b32 s72, s79, 11
    s_add_u32 s72, s72, 36864
    v_add_u32 v23, s72, v4
    v_xor_b32 v11, 64, v23
    s_lshl_b32 s72, s29, 18
    s_lshl_b32 s73, s30, 8
    s_add_u32 s90, s72, s73
    s_lshl_b32 s72, s79, 16
    s_add_u32 s90, s90, s72
    s_add_u32 s90, s90, 2097152
    s_add_u32 s91, s90, 32768
    s_mov_b32 s75, 0x3f803f80
    s_cmp_eq_u32 s28, 4
    s_cbranch_scc1 L_w4a
    s_waitcnt vmcnt(2)
    s_branch L_w4b
L_w4a:
    s_waitcnt vmcnt(10)
L_w4b:
    v_mov_b32 v4, 0
    buffer_load_dwordx2 v[6:7], v4, s[64:67], 0 offen sc1
    ds_write_b128 v22, v[48:51]
    ds_write_b128 v12, v[52:55]
    s_waitcnt lgkmcnt(0)
    s_barrier
    ds_read_b128 v[128:131], v23
    ds_read_b128 v[132:135], v11 offset:1024
    s_waitcnt lgkmcnt(1)
    buffer_store_dwordx4 v[128:131], v13, s[68:71], s90 offen sc1
    s_waitcnt lgkmcnt(0)
    buffer_store_dwordx4 v[132:135], v13, s[68:71], s91 offen sc1
    s_waitcnt vmcnt(3)
    s_cmp_lg_u32 s28, 4
    s_cbranch_scc1 L_aux_pub
    v_mov_b32 v100, 0
    v_mov_b32 v101, 0
    v_mov_b32 v102, 0
    v_mov_b32 v103, 0
    v_dot2_f32_bf16 v100, v64, s75, v100
    v_dot2_f32_bf16 v101, v65, s75, v101
    v_dot2_f32_bf16 v102, v66, s75, v102
    v_dot2_f32_bf16 v103, v67, s75, v103
    v_dot2_f32_bf16 v100, v68, s75, v100
    v_dot2_f32_bf16 v101, v69, s75, v101
    v_dot2_f32_bf16 v102, v70, s75, v102
    v_dot2_f32_bf16 v103, v71, s75, v103
    v_dot2_f32_bf16 v100, v72, s75, v100
    v_dot2_f32_bf16 v101, v73, s75, v101
    v_dot2_f32_bf16 v102, v74, s75, v102
    v_dot2_f32_bf16 v103, v75, s75, v103
    v_dot2_f32_bf16 v100, v76, s75, v100
    v_dot2_f32_bf16 v101, v77, s75, v101
    v_dot2_f32_bf16 v102, v78, s75, v102
    v_dot2_f32_bf16 v103, v79, s75, v103
    v_dot2_f32_bf16 v100, v80, s75, v100
    v_dot2_f32_bf16 v101, v81, s75, v101
    v_dot2_f32_bf16 v102, v82, s75, v102
    v_dot2_f32_bf16 v103, v83, s75, v103
    v_dot2_f32_bf16 v100, v84, s75, v100
    v_dot2_f32_bf16 v101, v85, s75, v101
    v_dot2_f32_bf16 v102, v86, s75, v102
    v_dot2_f32_bf16 v103, v87, s75, v103
    v_dot2_f32_bf16 v100, v88, s75, v100
    v_dot2_f32_bf16 v101, v89, s75, v101
    v_dot2_f32_bf16 v102, v90, s75, v102
    v_dot2_f32_bf16 v103, v91, s75, v103
    v_dot2_f32_bf16 v100, v92, s75, v100
    v_dot2_f32_bf16 v101, v93, s75, v101
    v_dot2_f32_bf16 v102, v94, s75, v102
    v_dot2_f32_bf16 v103, v95, s75, v103
    s_nop 2
    v_add_f32 v100, v100, v101
    v_add_f32 v102, v102, v103
    v_add_f32 v100, v100, v102
    s_nop 1
    v_add_f32_dpp v100, v100, v100 quad_perm:[1,0,3,2] row_mask:0xf bank_mask:0xf
    s_nop 1
    v_add_f32_dpp v100, v100, v100 quad_perm:[2,3,0,1] row_mask:0xf bank_mask:0xf
    s_nop 1
    v_add_f32_dpp v100, v100, v100 row_half_mirror row_mask:0xf bank_mask:0xf
    v_mul_f32 v100, 0x3b000000, v100
    v_mov_b32 v101, v100
    v_mov_b32 v102, 0
    v_mov_b32 v103, 0
    v_mov_b32 v104, 0
    v_mov_b32 v105, 0
    v_lshlrev_b32 v106, 16, v64
    v_and_b32 v107, 0xffff0000, v64
    v_pk_add_f32 v[106:107], v[106:107], v[100:101] neg_lo:[0,1] neg_hi:[0,1]
    v_pk_fma_f32 v[102:103], v[106:107], v[106:107], v[102:103]
    v_lshlrev_b32 v108, 16, v65
    v_and_b32 v109, 0xffff0000, v65
    v_pk_add_f32 v[108:109], v[108:109], v[100:101] neg_lo:[0,1] neg_hi:[0,1]
    v_pk_fma_f32 v[104:105], v[108:109], v[108:109], v[104:105]
    v_lshlrev_b32 v110, 16, v66
    v_and_b32 v111, 0xffff0000, v66
    v_pk_add_f32 v[110:111], v[110:111], v[100:101] neg_lo:[0,1] neg_hi:[0,1]
    v_pk_fma_f32 v[102:103], v[110:111], v[110:111], v[102:103]
    v_lshlrev_b32 v112, 16, v67
    v_and_b32 v113, 0xffff0000, v67
    v_pk_add_f32 v[112:113], v[112:113], v[100:101] neg_lo:[0,1] neg_hi:[0,1]
    v_pk_fma_f32 v[104:105], v[112:113], v[112:113], v[104:105]
    v_lshlrev_b32 v106, 16, v68
    v_and_b32 v107, 0xffff0000, v68
    v_pk_add_f32 v[106:107], v[106:107], v[100:101] neg_lo:[0,1] neg_hi:[0,1]
    v_pk_fma_f32 v[102:103], v[106:107], v[106:107], v[102:103]
    v_lshlrev_b32 v108, 16, v69
    v_and_b32 v109, 0xffff0000, v69
    v_pk_add_f32 v[108:109], v[108:109], v[100:101] neg_lo:[0,1] neg_hi:[0,1]
    v_pk_fma_f32 v[104:105], v[108:109], v[108:109], v[104:105]
    v_lshlrev_b32 v110, 16, v70
    v_and_b32 v111, 0xffff0000, v70
    v_pk_add_f32 v[110:111], v[110:111], v[100:101] neg_lo:[0,1] neg_hi:[0,1]
    v_pk_fma_f32 v[102:103], v[110:111], v[110:111], v[102:103]
    v_lshlrev_b32 v112, 16, v71
    v_and_b32 v113, 0xffff0000, v71
    v_pk_add_f32 v[112:113], v[112:113], v[100:101] neg_lo:[0,1] neg_hi:[0,1]
    v_pk_fma_f32 v[104:105], v[112:113], v[112:113], v[104:105]
    v_lshlrev_b32 v106, 16, v72
    v_and_b32 v107, 0xffff0000, v72
    v_pk_add_f32 v[106:107], v[106:107], v[100:101] neg_lo:[0,1] neg_hi:[0,1]
    v_pk_fma_f32 v[102:103], v[106:107], v[106:107], v[102:103]
    v_lshlrev_b32 v108, 16, v73
    v_and_b32 v109, 0xffff0000, v73
    v_pk_add_f32 v[108:109], v[108:109], v[100:101] neg_lo:[0,1] neg_hi:[0,1]
    v_pk_fma_f32 v[104:105], v[108:109], v[108:109], v[104:105]
    v_lshlrev_b32 v110, 16, v74
    v_and_b32 v111, 0xffff0000, v74
    v_pk_add_f32 v[110:111], v[110:111], v[100:101] neg_lo:[0,1] neg_hi:[0,1]
    v_pk_fma_f32 v[102:103], v[110:111], v[110:111], v[102:103]
    v_lshlrev_b32 v112, 16, v75
    v_and_b32 v113, 0xffff0000, v75
    v_pk_add_f32 v[112:113], v[112:113], v[100:101] neg_lo:[0,1] neg_hi:[0,1]
    v_pk_fma_f32 v[104:105], v[112:113], v[112:113], v[104:105]
    v_lshlrev_b32 v106, 16, v76
    v_and_b32 v107, 0xffff0000, v76
    v_pk_add_f32 v[106:107], v[106:107], v[100:101] neg_lo:[0,1] neg_hi:[0,1]
    v_pk_fma_f32 v[102:103], v[106:107], v[106:107], v[102:103]
    v_lshlrev_b32 v108, 16, v77
    v_and_b32 v109, 0xffff0000, v77
    v_pk_add_f32 v[108:109], v[108:109], v[100:101] neg_lo:[0,1] neg_hi:[0,1]
    v_pk_fma_f32 v[104:105], v[108:109], v[108:109], v[104:105]
    v_lshlrev_b32 v110, 16, v78
    v_and_b32 v111, 0xffff0000, v78
    v_pk_add_f32 v[110:111], v[110:111], v[100:101] neg_lo:[0,1] neg_hi:[0,1]
    v_pk_fma_f32 v[102:103], v[110:111], v[110:111], v[102:103]
    v_lshlrev_b32 v112, 16, v79
    v_and_b32 v113, 0xffff0000, v79
    v_pk_add_f32 v[112:113], v[112:113], v[100:101] neg_lo:[0,1] neg_hi:[0,1]
    v_pk_fma_f32 v[104:105], v[112:113], v[112:113], v[104:105]
    v_lshlrev_b32 v106, 16, v80
    v_and_b32 v107, 0xffff0000, v80
    v_pk_add_f32 v[106:107], v[106:107], v[100:101] neg_lo:[0,1] neg_hi:[0,1]
    v_pk_fma_f32 v[102:103], v[106:107], v[106:107], v[102:103]
    v_lshlrev_b32 v108, 16, v81
    v_and_b32 v109, 0xffff0000, v81
    v_pk_add_f32 v[108:109], v[108:109], v[100:101] neg_lo:[0,1] neg_hi:[0,1]
    v_pk_fma_f32 v[104:105], v[108:109], v[108:109], v[104:105]
    v_lshlrev_b32 v110, 16, v82
    v_and_b32 v111, 0xffff0000, v82
    v_pk_add_f32 v[110:111], v[110:111], v[100:101] neg_lo:[0,1] neg_hi:[0,1]
    v_pk_fma_f32 v[102:103], v[110:111], v[110:111], v[102:103]
    v_lshlrev_b32 v112, 16, v83
    v_and_b32 v113, 0xffff0000, v83
    v_pk_add_f32 v[112:113], v[112:113], v[100:101] neg_lo:[0,1] neg_hi:[0,1]
    v_pk_fma_f32 v[104:105], v[112:113], v[112:113], v[104:105]
    v_lshlrev_b32 v106, 16, v84
    v_and_b32 v107, 0xffff0000, v84
    v_pk_add_f32 v[106:107], v[106:107], v[100:101] neg_lo:[0,1] neg_hi:[0,1]
    v_pk_fma_f32 v[102:103], v[106:107], v[106:107], v[102:103]
    v_lshlrev_b32 v108, 16, v85
    v_and_b32 v109, 0xffff0000, v85
    v_pk_add_f32 v[108:109], v[108:109], v[100:101] neg_lo:[0,1] neg_hi:[0,1]
    v_pk_fma_f32 v[104:105], v[108:109], v[108:109], v[104:105]
    v_lshlrev_b32 v110, 16, v86
    v_and_b32 v111, 0xffff0000, v86
    v_pk_add_f32 v[110:111], v[110:111], v[100:101] neg_lo:[0,1] neg_hi:[0,1]
    v_pk_fma_f32 v[102:103], v[110:111], v[110:111], v[102:103]
    v_lshlrev_b32 v112, 16, v87
    v_and_b32 v113, 0xffff0000, v87
    v_pk_add_f32 v[112:113], v[112:113], v[100:101] neg_lo:[0,1] neg_hi:[0,1]
    v_pk_fma_f32 v[104:105], v[112:113], v[112:113], v[104:105]
    v_lshlrev_b32 v106, 16, v88
    v_and_b32 v107, 0xffff0000, v88
    v_pk_add_f32 v[106:107], v[106:107], v[100:101] neg_lo:[0,1] neg_hi:[0,1]
    v_pk_fma_f32 v[102:103], v[106:107], v[106:107], v[102:103]
    v_lshlrev_b32 v108, 16, v89
    v_and_b32 v109, 0xffff0000, v89
    v_pk_add_f32 v[108:109], v[108:109], v[100:101] neg_lo:[0,1] neg_hi:[0,1]
    v_pk_fma_f32 v[104:105], v[108:109], v[108:109], v[104:105]
    v_lshlrev_b32 v110, 16, v90
    v_and_b32 v111, 0xffff0000, v90
    v_pk_add_f32 v[110:111], v[110:111], v[100:101] neg_lo:[0,1] neg_hi:[0,1]
    v_pk_fma_f32 v[102:103], v[110:111], v[110:111], v[102:103]
    v_lshlrev_b32 v112, 16, v91
    v_and_b32 v113, 0xffff0000, v91
    v_pk_add_f32 v[112:113], v[112:113], v[100:101] neg_lo:[0,1] neg_hi:[0,1]
    v_pk_fma_f32 v[104:105], v[112:113], v[112:113], v[104:105]
    v_lshlrev_b32 v106, 16, v92
    v_and_b32 v107, 0xffff0000, v92
    v_pk_add_f32 v[106:107], v[106:107], v[100:101] neg_lo:[0,1] neg_hi:[0,1]
    v_pk_fma_f32 v[102:103], v[106:107], v[106:107], v[102:103]
    v_lshlrev_b32 v108, 16, v93
    v_and_b32 v109, 0xffff0000, v93
    v_pk_add_f32 v[108:109], v[108:109], v[100:101] neg_lo:[0,1] neg_hi:[0,1]
    v_pk_fma_f32 v[104:105], v[108:109], v[108:109], v[104:105]
    v_lshlrev_b32 v110, 16, v94
    v_and_b32 v111, 0xffff0000, v94
    v_pk_add_f32 v[110:111], v[110:111], v[100:101] neg_lo:[0,1] neg_hi:[0,1]
    v_pk_fma_f32 v[102:103], v[110:111], v[110:111], v[102:103]
    v_lshlrev_b32 v112, 16, v95
    v_and_b32 v113, 0xffff0000, v95
    v_pk_add_f32 v[112:113], v[112:113], v[100:101] neg_lo:[0,1] neg_hi:[0,1]
    v_pk_fma_f32 v[104:105], v[112:113], v[112:113], v[104:105]
    v_add_f32 v102, v102, v103
    v_add_f32 v104, v104, v105
    v_add_f32 v102, v102, v104
    s_nop 1
    v_add_f32_dpp v102, v102, v102 quad_perm:[1,0,3,2] row_mask:0xf bank_mask:0xf
    s_nop 1
    v_add_f32_dpp v102, v102, v102 quad_perm:[2,3,0,1] row_mask:0xf bank_mask:0xf
    s_nop 1
    v_add_f32_dpp v102, v102, v102 row_half_mirror row_mask:0xf bank_mask:0xf
    v_mul_f32 v102, 0x3b000000, v102
    v_cvt_pk_bf16_f32 v104, v100, v102
    v_and_b32 v105, 0xffff0000, v104
    v_add_f32 v105, 0x3727c5ac, v105
    v_cvt_pk_bf16_f32 v105, v105, v105
    v_and_b32 v105, 0xffff0000, v105
    v_sqrt_f32 v105, v105
    s_nop 0
    v_cvt_pk_bf16_f32 v105, v104, v105
    v_and_b32 v104, 0xffff, v104
    v_and_b32 v105, 0xffff0000, v105
    v_or_b32 v104, v104, v105
    v_lshrrev_b32 v24, 3, v1
    v_lshlrev_b32 v24, 2, v24
    s_lshl_b32 s72, s2, 5
    s_add_u32 s72, s72, 4194304
    s_mov_b32 exec_lo, 0x01010101
    s_mov_b32 exec_hi, 0x01010101
    buffer_store_dword v104, v24, s[68:71], s72 offen sc1
    s_mov_b64 exec, -1
L_aux_pub:
    s_lshl_b32 s72, s79, 10
    s_add_u32 s72, s72, s80
    v_add_u32 v40, s72, v5
    ds_write_b128 v40, v[16:19] offset:32
    v_alignbit_b32 v24, v17, v16, 16
    v_alignbit_b32 v25, v18, v17, 16
    v_alignbit_b32 v26, v19, v18, 16
    v_alignbit_b32 v27, v20, v19, 16
    v_mov_b32 v28, v17
    v_mov_b32 v29, v18
    v_mov_b32 v30, v19
    v_mov_b32 v31, v20
    ds_write_b128 v40, v[24:27] offset:4192
    v_mov_b32 v32, v25
    v_mov_b32 v33, v26
    v_mov_b32 v34, v27
    v_alignbit_b32 v35, v21, v20, 16
    ds_write_b128 v40, v[28:31] offset:8352
    ds_write_b128 v40, v[32:35] offset:12512
    s_cmp_lg_u32 s79, 0
    s_cbranch_scc1 Lnofix_11
    s_mov_b64 exec, 1
    v_lshlrev_b32 v37, 16, v16
    v_mov_b32 v36, 0
    v_mov_b32 v38, 0
    v_mov_b32 v39, v16
    v_mov_b32 v42, v37
    v_mov_b32 v43, v24
    ds_write_b64 v40, v[36:37] offset:4184
    ds_write_b64 v40, v[38:39] offset:8344
    ds_write_b64 v40, v[42:43] offset:12504
    s_mov_b64 exec, -1
Lnofix_11:
    s_waitcnt vmcnt(0)
    s_mov_b32 s72, 40000
Ltag_12:
    v_readfirstlane_b32 s73, v6
    s_cmp_lg_u32 s73, 0
    s_cbranch_scc1 Ltagd_13
    s_sub_u32 s72, s72, 1
    s_cmp_eq_u32 s72, 0
    s_cbranch_scc1 Ltagd_13
    v_mov_b32 v4, 0
    buffer_load_dwordx2 v[6:7], v4, s[64:67], 0 offen sc1
    s_waitcnt vmcnt(0)
    s_branch Ltag_12
Ltagd_13:
    v_mov_b32 v24, 157184
    v_mov_b32 v25, 1
    s_mov_b64 exec, 1
    ds_add_rtn_u32 v25, v24, v25
    s_mov_b64 exec, -1
    s_waitcnt lgkmcnt(0)
    v_readfirstlane_b32 s72, v25
    s_cmp_lg_u32 s72, 3
    s_cbranch_scc1 Lnfx_14
    s_lshl_b32 s73, s2, 7
    s_add_u32 s73, s73, 21102592
    v_mov_b32 v4, 0
    s_mov_b64 exec, 1
    buffer_store_dwordx2 v[6:7], v4, s[68:71], s73 offen sc1
    s_mov_b64 exec, -1
Lnfx_14:
L_p0_join:
    s_lshr_b32 s84, s30, 3
    s_lshr_b32 s72, s29, 1
    s_lshl_b32 s72, s72, 2
    s_add_u32 s84, s84, s72
    s_and_b32 s85, s30, 7
    s_and_b32 s72, s29, 1
    s_lshl_b32 s72, s72, 3
    s_add_u32 s85, s85, s72
    v_mov_b32 v214, 2146435072
    v_mov_b32 v215, 2146435072
    v_mov_b32 v234, 2146435072
    s_mul_i32 s88, s85, 224
    s_and_b32 s94, s85, 1
    s_lshr_b32 s86, s28, 1
    s_and_b32 s87, s28, 1
    s_lshr_b32 s72, s85, 1
    s_lshl_b32 s72, s72, 1
    s_add_u32 s72, s72, s87
    s_mul_i32 s31, s72, 56
    s_mul_i32 s72, s86, 14
    s_add_u32 s31, s31, s72
    s_lshl_b32 s31, s31, 11
    s_add_u32 s31, s31, 10485760
    v_add_u32 v10, 1, v2
    v_and_b32 v11, 3, v10
    v_mul_u32_u24 v11, 4160, v11
    v_lshrrev_b32 v10, 2, v10
    v_lshl_add_u32 v10, v10, 3, v11
    v_lshlrev_b32 v11, 4, v3
    v_sub_u32 v10, v10, v11
    s_lshl_b32 s72, s79, 7
    s_add_u32 s73, s80, s72
    s_add_u32 s73, s73, 48
    v_add_u32 v10, s73, v10
    v_lshl_add_u32 v11, v2, 5, v11
    s_add_u32 s73, s82, 416
    s_sub_u32 s73, s73, s72
    v_add_u32 v11, s73, v11
    v_lshlrev_b32 v13, 6, v2
    v_lshl_add_u32 v13, v3, 4, v13
    s_lshl_b32 s72, s28, 10
    s_add_u32 s72, s72, 94208
    v_add_u32 v13, s72, v13
    s_lshl_b32 s72, s83, 2
    s_add_u32 s14, s14, s72
    s_addc_u32 s15, s15, 0
    s_load_dword s93, s[14:15], 0
    s_waitcnt lgkmcnt(0)
    v_mov_b32 v16, 0
    v_mov_b32 v17, 0
    v_mov_b32 v18, 0
    v_mov_b32 v19, 0
    v_mov_b32 v20, 0
    v_mov_b32 v21, 0
    v_mov_b32 v22, 0
    v_mov_b32 v23, 0
    v_mov_b32 v24, 0
    v_mov_b32 v25, 0
    v_mov_b32 v26, 0
    v_mov_b32 v27, 0
    v_mov_b32 v28, 0
    v_mov_b32 v29, 0
    v_mov_b32 v30, 0
    v_mov_b32 v31, 0
    v_mov_b32 v32, 0
    v_mov_b32 v33, 0
    v_mov_b32 v34, 0
    v_mov_b32 v35, 0
    v_mov_b32 v36, 0
    v_mov_b32 v37, 0
    v_mov_b32 v38, 0
    v_mov_b32 v39, 0
    v_mov_b32 v40, 0
    v_mov_b32 v41, 0
    v_mov_b32 v42, 0
    v_mov_b32 v43, 0
    v_mov_b32 v44, 0
    v_mov_b32 v45, 0
    v_mov_b32 v46, 0
    v_mov_b32 v47, 0
    s_barrier
    s_cmp_eq_u32 s28, 3
    s_cbranch_scc1 L_conv_w3
    s_add_u32 s72, s28, 1
    s_and_b32 s72, s72, 7
    s_cmp_gt_u32 s72, 1
    s_cbranch_scc1 L_conv_t
    v_lshrrev_b32 v208, 5, v1
    v_and_b32 v209, 31, v1
    v_lshlrev_b32 v212, 12, v208
    v_lshl_add_u32 v212, v209, 2, v212
    v_lshrrev_b32 v213, 4, v209
    v_mul_u32_u24 v213, 114688, v213
    v_and_b32 v209, 15, v209
    v_lshl_add_u32 v213, v209, 4, v213
    v_lshl_add_u32 v213, v208, 8, v213
    v_mov_b32 v214, 2146435072
    v_mov_b32 v215, 2146435072
    s_mov_b32 s95, 0
    s_mul_i32 s89, s2, 3
    s_lshr_b32 s72, s28, 2
    s_add_u32 s89, s89, s72
    s_mul_i32 s73, s89, 2341
    s_lshr_b32 s73, s73, 18
    s_mul_i32 s72, s73, 112
    s_sub_u32 s72, s89, s72
    s_and_b32 s77, s72, 1
    s_lshr_b32 s72, s72, 1
    s_lshl_b32 s90, s72, 15
    s_lshl_b32 s91, s73, 7
    s_add_u32 s90, s90, s91
    s_lshl_b32 s91, s77, 13
    s_add_u32 s90, s90, s91
    buffer_load_dword v192, v212, s[56:59], s90 offen offset:0 nt
    buffer_load_dword v193, v212, s[56:59], s90 offen offset:1024 nt
    buffer_load_dword v194, v212, s[56:59], s90 offen offset:2048 nt
    buffer_load_dword v195, v212, s[56:59], s90 offen offset:3072 nt
    s_add_u32 s90, s90, 16384
    buffer_load_dword v196, v212, s[56:59], s90 offen offset:0 nt
    buffer_load_dword v197, v212, s[56:59], s90 offen offset:1024 nt
    buffer_load_dword v198, v212, s[56:59], s90 offen offset:2048 nt
    buffer_load_dword v199, v212, s[56:59], s90 offen offset:3072 nt
    s_mul_i32 s73, s73, 112
    s_add_u32 s73, s73, s72
    s_lshl_b32 s73, s73, 11
    s_lshl_b32 s77, s77, 9
    s_add_u32 s73, s73, s77
    v_add_u32 v214, s73, v213
    s_add_u32 s89, s89, 1
    s_add_u32 s72, s2, 768
    s_cmp_eq_u32 s28, 0
    s_cselect_b32 s89, s72, s89
    s_cmp_ge_u32 s89, 896
    s_cbranch_scc1 Lpkx_15
    s_mov_b32 s95, 1
    s_mul_i32 s73, s89, 2341
    s_lshr_b32 s73, s73, 18
    s_mul_i32 s72, s73, 112
    s_sub_u32 s72, s89, s72
    s_and_b32 s77, s72, 1
    s_lshr_b32 s72, s72, 1
    s_lshl_b32 s90, s72, 15
    s_lshl_b32 s91, s73, 7
    s_add_u32 s90, s90, s91
    s_lshl_b32 s91, s77, 13
    s_add_u32 s90, s90, s91
    buffer_load_dword v200, v212, s[56:59], s90 offen offset:0 nt
    buffer_load_dword v201, v212, s[56:59], s90 offen offset:1024 nt
    buffer_load_dword v202, v212, s[56:59], s90 offen offset:2048 nt
    buffer_load_dword v203, v212, s[56:59], s90 offen offset:3072 nt
    s_add_u32 s90, s90, 16384
    buffer_load_dword v204, v212, s[56:59], s90 offen offset:0 nt
    buffer_load_dword v205, v212, s[56:59], s90 offen offset:1024 nt
    buffer_load_dword v206, v212, s[56:59], s90 offen offset:2048 nt
    buffer_load_dword v207, v212, s[56:59], s90 offen offset:3072 nt
    s_mul_i32 s73, s73, 112
    s_add_u32 s73, s73, s72
    s_lshl_b32 s73, s73, 11
    s_lshl_b32 s77, s77, 9
    s_add_u32 s73, s73, s77
    v_add_u32 v215, s73, v213
Lpkx_15:
    s_branch L_conv_t
L_conv_w3:
    s_mov_b32 s73, 21102592
    s_add_u32 s77, s73, 0
    buffer_load_dwordx2 v[184:185], v14, s[68:71], s77 offen sc1
    s_add_u32 s77, s73, 8192
    buffer_load_dwordx2 v[186:187], v14, s[68:71], s77 offen sc1
    s_add_u32 s77, s73, 16384
    buffer_load_dwordx2 v[188:189], v14, s[68:71], s77 offen sc1
    s_add_u32 s77, s73, 24576
    buffer_load_dwordx2 v[190:191], v14, s[68:71], s77 offen sc1
    ds_read_b64 v[48:49], v10 offset:0
    ds_read_b64 v[50:51], v10 offset:8
    ds_read_b128 v[80:83], v11 offset:64
    ds_read_b64 v[52:53], v10 offset:512
    ds_read_b64 v[54:55], v10 offset:520
    ds_read_b128 v[84:87], v11 offset:576
    ds_read_b64 v[56:57], v10 offset:1024
    ds_read_b64 v[58:59], v10 offset:1032
    ds_read_b128 v[88:91], v11 offset:1088
    ds_read_b64 v[60:61], v10 offset:1536
    ds_read_b64 v[62:63], v10 offset:1544
    ds_read_b128 v[92:95], v11 offset:1600
    ds_read_b64 v[64:65], v10 offset:2048
    ds_read_b64 v[66:67], v10 offset:2056
    ds_read_b128 v[96:99], v11 offset:2112
    s_waitcnt lgkmcnt(12)
    v_mfma_f32_16x16x32_bf16 v[16:19], v[48:51], v[80:83], v[16:19]
    ds_read_b64 v[68:69], v10 offset:2560
    s_waitcnt lgkmcnt(10)
    v_mfma_f32_16x16x32_bf16 v[20:23], v[48:51], v[84:87], v[20:23]
    ds_read_b64 v[70:71], v10 offset:2568
    v_mfma_f32_16x16x32_bf16 v[20:23], v[52:55], v[80:83], v[20:23]
    ds_read_b128 v[100:103], v11 offset:2624
    s_waitcnt lgkmcnt(9)
    v_mfma_f32_16x16x32_bf16 v[24:27], v[48:51], v[88:91], v[24:27]
    ds_read_b64 v[72:73], v10 offset:3072
    v_mfma_f32_16x16x32_bf16 v[24:27], v[52:55], v[84:87], v[24:27]
    ds_read_b64 v[74:75], v10 offset:3080
    v_mfma_f32_16x16x32_bf16 v[24:27], v[56:59], v[80:83], v[24:27]
    ds_read_b128 v[104:107], v11 offset:3136
    s_waitcnt lgkmcnt(9)
    v_mfma_f32_16x16x32_bf16 v[28:31], v[48:51], v[92:95], v[28:31]
    ds_read_b64 v[76:77], v10 offset:3584
    v_mfma_f32_16x16x32_bf16 v[28:31], v[52:55], v[88:91], v[28:31]
    ds_read_b64 v[78:79], v10 offset:3592
    v_mfma_f32_16x16x32_bf16 v[28:31], v[56:59], v[84:87], v[28:31]
    ds_read_b128 v[108:111], v11 offset:3648
    v_mfma_f32_16x16x32_bf16 v[28:31], v[60:63], v[80:83], v[28:31]
    s_waitcnt lgkmcnt(9)
    v_mfma_f32_16x16x32_bf16 v[32:35], v[48:51], v[96:99], v[32:35]
    ds_read_b64 v[112:113], v10 offset:64
    v_mfma_f32_16x16x32_bf16 v[32:35], v[52:55], v[92:95], v[32:35]
    ds_read_b64 v[114:115], v10 offset:72
    v_mfma_f32_16x16x32_bf16 v[32:35], v[56:59], v[88:91], v[32:35]
    ds_read_b128 v[144:147], v11 offset:0
    v_mfma_f32_16x16x32_bf16 v[32:35], v[60:63], v[84:87], v[32:35]
    v_mfma_f32_16x16x32_bf16 v[32:35], v[64:67], v[80:83], v[32:35]
    s_waitcnt lgkmcnt(9)
    v_mfma_f32_16x16x32_bf16 v[36:39], v[48:51], v[100:103], v[36:39]
    ds_read_b64 v[116:117], v10 offset:576
    v_mfma_f32_16x16x32_bf16 v[36:39], v[52:55], v[96:99], v[36:39]
    ds_read_b64 v[118:119], v10 offset:584
    v_mfma_f32_16x16x32_bf16 v[36:39], v[56:59], v[92:95], v[36:39]
    ds_read_b128 v[148:151], v11 offset:512
    v_mfma_f32_16x16x32_bf16 v[36:39], v[60:63], v[88:91], v[36:39]
    v_mfma_f32_16x16x32_bf16 v[36:39], v[64:67], v[84:87], v[36:39]
    v_mfma_f32_16x16x32_bf16 v[36:39], v[68:71], v[80:83], v[36:39]
    s_mov_b64 s[4:5], -1
    s_mov_b64 s[6:7], -1
    s_mov_b64 s[8:9], -1
    s_mov_b64 s[16:17], -1
    s_mov_b32 s72, 40000
    s_branch Lpnc_18
Lpn_16:
    s_mov_b64 exec, s[4:5]
    s_add_u32 s77, s73, 0
    s_cbranch_execz Lsk_19
    buffer_load_dwordx2 v[184:185], v14, s[68:71], s77 offen sc1
Lsk_19:
    s_mov_b64 exec, s[6:7]
    s_add_u32 s77, s73, 8192
    s_cbranch_execz Lsk_20
    buffer_load_dwordx2 v[186:187], v14, s[68:71], s77 offen sc1
Lsk_20:
    s_mov_b64 exec, s[8:9]
    s_add_u32 s77, s73, 16384
    s_cbranch_execz Lsk_21
    buffer_load_dwordx2 v[188:189], v14, s[68:71], s77 offen sc1
Lsk_21:
    s_mov_b64 exec, s[16:17]
    s_add_u32 s77, s73, 24576
    s_cbranch_execz Lsk_22
    buffer_load_dwordx2 v[190:191], v14, s[68:71], s77 offen sc1
Lsk_22:
    s_mov_b64 exec, -1
Lpnc_18:
    s_waitcnt vmcnt(0)
    v_cmp_ne_u64 vcc, v[184:185], v[6:7]
    s_and_b64 s[4:5], s[4:5], vcc
    v_cmp_ne_u64 vcc, v[186:187], v[6:7]
    s_and_b64 s[6:7], s[6:7], vcc
    v_cmp_ne_u64 vcc, v[188:189], v[6:7]
    s_and_b64 s[8:9], s[8:9], vcc
    v_cmp_ne_u64 vcc, v[190:191], v[6:7]
    s_and_b64 s[16:17], s[16:17], vcc
    s_mov_b64 s[10:11], s[4:5]
    s_or_b64 s[10:11], s[10:11], s[6:7]
    s_or_b64 s[10:11], s[10:11], s[8:9]
    s_or_b64 s[10:11], s[10:11], s[16:17]
    s_sub_u32 s72, s72, 1
    s_cmp_eq_u32 s72, 0
    s_cbranch_scc1 Lpnd_17
    s_cmp_eq_u64 s[10:11], 0
    s_cbranch_scc1 Lpnd_17
    s_branch Lpn_16
Lpnd_17:
    s_lshl_b32 s73, s83, 13
    s_add_u32 s73, s73, 2097152
    s_mov_b32 m0, 94208
    s_nop 0
    buffer_load_dwordx4 v5, s[68:71], s73 offen offset:0 sc1 lds
    buffer_load_dwordx4 v5, s[68:71], s73 offen offset:1024 sc1 lds
    buffer_load_dwordx4 v5, s[68:71], s73 offen offset:2048 sc1 lds
    buffer_load_dwordx4 v5, s[68:71], s73 offen offset:3072 sc1 lds
    s_add_u32 s73, s73, 4096
    s_mov_b32 m0, 98304
    s_nop 0
    buffer_load_dwordx4 v5, s[68:71], s73 offen offset:0 sc1 lds
    buffer_load_dwordx4 v5, s[68:71], s73 offen offset:1024 sc1 lds
    buffer_load_dwordx4 v5, s[68:71], s73 offen offset:2048 sc1 lds
    buffer_load_dwordx4 v5, s[68:71], s73 offen offset:3072 sc1 lds
    s_mov_b32 s73, 4194304
    s_mov_b32 m0, 102400
    s_nop 0
    buffer_load_dwordx4 v5, s[68:71], s73 offen offset:0 sc1 lds
    buffer_load_dwordx4 v5, s[68:71], s73 offen offset:1024 sc1 lds
    buffer_load_dwordx4 v5, s[68:71], s73 offen offset:2048 sc1 lds
    buffer_load_dwordx4 v5, s[68:71], s73 offen offset:3072 sc1 lds
    s_mov_b32 s73, 4198400
    s_mov_b32 m0, 106496
    s_nop 0
    buffer_load_dwordx4 v5, s[68:71], s73 offen offset:0 sc1 lds
    buffer_load_dwordx4 v5, s[68:71], s73 offen offset:1024 sc1 lds
    buffer_load_dwordx4 v5, s[68:71], s73 offen offset:2048 sc1 lds
    buffer_load_dwordx4 v5, s[68:71], s73 offen offset:3072 sc1 lds
    s_waitcnt lgkmcnt(9)
    v_mfma_f32_16x16x32_bf16 v[40:43], v[48:51], v[104:107], v[40:43]
    ds_read_b64 v[120:121], v10 offset:1088
    v_mfma_f32_16x16x32_bf16 v[40:43], v[52:55], v[100:103], v[40:43]
    ds_read_b64 v[122:123], v10 offset:1096
    v_mfma_f32_16x16x32_bf16 v[40:43], v[56:59], v[96:99], v[40:43]
    ds_read_b128 v[152:155], v11 offset:1024
    v_mfma_f32_16x16x32_bf16 v[40:43], v[60:63], v[92:95], v[40:43]
    v_mfma_f32_16x16x32_bf16 v[40:43], v[64:67], v[88:91], v[40:43]
    v_mfma_f32_16x16x32_bf16 v[40:43], v[68:71], v[84:87], v[40:43]
    v_mfma_f32_16x16x32_bf16 v[40:43], v[72:75], v[80:83], v[40:43]
    s_waitcnt lgkmcnt(9)
    v_mfma_f32_16x16x32_bf16 v[44:47], v[48:51], v[108:111], v[44:47]
    ds_read_b64 v[124:125], v10 offset:1600
    v_mfma_f32_16x16x32_bf16 v[44:47], v[52:55], v[104:107], v[44:47]
    ds_read_b64 v[126:127], v10 offset:1608
    v_mfma_f32_16x16x32_bf16 v[44:47], v[56:59], v[100:103], v[44:47]
    ds_read_b128 v[156:159], v11 offset:1536
    v_mfma_f32_16x16x32_bf16 v[44:47], v[60:63], v[96:99], v[44:47]
    v_mfma_f32_16x16x32_bf16 v[44:47], v[64:67], v[92:95], v[44:47]
    v_mfma_f32_16x16x32_bf16 v[44:47], v[68:71], v[88:91], v[44:47]
    v_mfma_f32_16x16x32_bf16 v[44:47], v[72:75], v[84:87], v[44:47]
    v_mfma_f32_16x16x32_bf16 v[44:47], v[76:79], v[80:83], v[44:47]
    s_waitcnt lgkmcnt(9)
    v_mfma_f32_16x16x32_bf16 v[16:19], v[112:115], v[144:147], v[16:19]
    ds_read_b64 v[128:129], v10 offset:2112
    s_waitcnt lgkmcnt(7)
    v_mfma_f32_16x16x32_bf16 v[20:23], v[112:115], v[148:151], v[20:23]
    ds_read_b64 v[130:131], v10 offset:2120
    v_mfma_f32_16x16x32_bf16 v[20:23], v[116:119], v[144:147], v[20:23]
    ds_read_b128 v[160:163], v11 offset:2048
    s_waitcnt lgkmcnt(6)
    v_mfma_f32_16x16x32_bf16 v[24:27], v[112:115], v[152:155], v[24:27]
    ds_read_b64 v[132:133], v10 offset:2624
    v_mfma_f32_16x16x32_bf16 v[24:27], v[116:119], v[148:151], v[24:27]
    ds_read_b64 v[134:135], v10 offset:2632
    v_mfma_f32_16x16x32_bf16 v[24:27], v[120:123], v[144:147], v[24:27]
    ds_read_b128 v[164:167], v11 offset:2560
    s_waitcnt lgkmcnt(6)
    v_mfma_f32_16x16x32_bf16 v[28:31], v[112:115], v[156:159], v[28:31]
    ds_read_b64 v[136:137], v10 offset:3136
    v_mfma_f32_16x16x32_bf16 v[28:31], v[116:119], v[152:155], v[28:31]
    ds_read_b64 v[138:139], v10 offset:3144
    v_mfma_f32_16x16x32_bf16 v[28:31], v[120:123], v[148:151], v[28:31]
    ds_read_b128 v[168:171], v11 offset:3072
    v_mfma_f32_16x16x32_bf16 v[28:31], v[124:127], v[144:147], v[28:31]
    s_waitcnt lgkmcnt(6)
    v_mfma_f32_16x16x32_bf16 v[32:35], v[112:115], v[160:163], v[32:35]
    ds_read_b64 v[140:141], v10 offset:3648
    v_mfma_f32_16x16x32_bf16 v[32:35], v[116:119], v[156:159], v[32:35]
    ds_read_b64 v[142:143], v10 offset:3656
    v_mfma_f32_16x16x32_bf16 v[32:35], v[120:123], v[152:155], v[32:35]
    ds_read_b128 v[172:175], v11 offset:3584
    v_mfma_f32_16x16x32_bf16 v[32:35], v[124:127], v[148:151], v[32:35]
    v_mfma_f32_16x16x32_bf16 v[32:35], v[128:131], v[144:147], v[32:35]
    s_waitcnt lgkmcnt(6)
    v_mfma_f32_16x16x32_bf16 v[36:39], v[112:115], v[164:167], v[36:39]
    v_mfma_f32_16x16x32_bf16 v[36:39], v[116:119], v[160:163], v[36:39]
    v_mfma_f32_16x16x32_bf16 v[36:39], v[120:123], v[156:159], v[36:39]
    v_mfma_f32_16x16x32_bf16 v[36:39], v[124:127], v[152:155], v[36:39]
    v_mfma_f32_16x16x32_bf16 v[36:39], v[128:131], v[148:151], v[36:39]
    v_mfma_f32_16x16x32_bf16 v[36:39], v[132:135], v[144:147], v[36:39]
    s_waitcnt lgkmcnt(3)
    v_mfma_f32_16x16x32_bf16 v[40:43], v[112:115], v[168:171], v[40:43]
    v_mfma_f32_16x16x32_bf16 v[40:43], v[116:119], v[164:167], v[40:43]
    v_mfma_f32_16x16x32_bf16 v[40:43], v[120:123], v[160:163], v[40:43]
    v_mfma_f32_16x16x32_bf16 v[40:43], v[124:127], v[156:159], v[40:43]
    v_mfma_f32_16x16x32_bf16 v[40:43], v[128:131], v[152:155], v[40:43]
    v_mfma_f32_16x16x32_bf16 v[40:43], v[132:135], v[148:151], v[40:43]
    v_mfma_f32_16x16x32_bf16 v[40:43], v[136:139], v[144:147], v[40:43]
    s_waitcnt lgkmcnt(0)
    v_mfma_f32_16x16x32_bf16 v[44:47], v[112:115], v[172:175], v[44:47]
    v_mfma_f32_16x16x32_bf16 v[44:47], v[116:119], v[168:171], v[44:47]
    v_mfma_f32_16x16x32_bf16 v[44:47], v[120:123], v[164:167], v[44:47]
    v_mfma_f32_16x16x32_bf16 v[44:47], v[124:127], v[160:163], v[44:47]
    v_mfma_f32_16x16x32_bf16 v[44:47], v[128:131], v[156:159], v[44:47]
    v_mfma_f32_16x16x32_bf16 v[44:47], v[132:135], v[152:155], v[44:47]
    v_mfma_f32_16x16x32_bf16 v[44:47], v[136:139], v[148:151], v[44:47]
    v_mfma_f32_16x16x32_bf16 v[44:47], v[140:143], v[144:147], v[44:47]
    s_branch L_conv_red
L_conv_t:
    s_mul_i32 s89, s30, 57344
    s_cmp_eq_u32 s28, 2
    s_cselect_b32 s73, 3, s79
    s_mul_i32 s72, s73, 14336
    s_add_u32 s89, s89, s72
    s_and_b32 s72, s29, 1
    s_mul_i32 s72, s72, 1792
    s_add_u32 s89, s89, s72
    v_mul_u32_u24 v234, 3584, v3
    v_min_u32 v235, 13, v2
    v_lshl_add_u32 v234, v235, 7, v234
L_conv_go:
    ds_read_b64 v[48:49], v10 offset:0
    ds_read_b64 v[50:51], v10 offset:8
    ds_read_b128 v[80:83], v11 offset:64
    ds_read_b64 v[52:53], v10 offset:512
    ds_read_b64 v[54:55], v10 offset:520
    ds_read_b128 v[84:87], v11 offset:576
    ds_read_b64 v[56:57], v10 offset:1024
    ds_read_b64 v[58:59], v10 offset:1032
    ds_read_b128 v[88:91], v11 offset:1088
    ds_read_b64 v[60:61], v10 offset:1536
    ds_read_b64 v[62:63], v10 offset:1544
    ds_read_b128 v[92:95], v11 offset:1600
    ds_read_b64 v[64:65], v10 offset:2048
    ds_read_b64 v[66:67], v10 offset:2056
    ds_read_b128 v[96:99], v11 offset:2112
    s_cmp_lg_u32 s28, 4
    s_cbranch_scc1 Ltk_23
    s_add_u32 s72, s89, 0
    buffer_load_dword v232, v234, s[52:55], s72 offen
Ltk_23:
    s_waitcnt lgkmcnt(12)
    v_mfma_f32_16x16x32_bf16 v[16:19], v[48:51], v[80:83], v[16:19]
    ds_read_b64 v[68:69], v10 offset:2560
    s_waitcnt lgkmcnt(10)
    v_mfma_f32_16x16x32_bf16 v[20:23], v[48:51], v[84:87], v[20:23]
    ds_read_b64 v[70:71], v10 offset:2568
    v_mfma_f32_16x16x32_bf16 v[20:23], v[52:55], v[80:83], v[20:23]
    ds_read_b128 v[100:103], v11 offset:2624
    s_cmp_lg_u32 s28, 2
    s_cbranch_scc1 Ltk_24
    s_add_u32 s72, s89, 0
    buffer_load_dword v232, v234, s[52:55], s72 offen
Ltk_24:
    s_waitcnt lgkmcnt(9)
    v_mfma_f32_16x16x32_bf16 v[24:27], v[48:51], v[88:91], v[24:27]
    ds_read_b64 v[72:73], v10 offset:3072
    v_mfma_f32_16x16x32_bf16 v[24:27], v[52:55], v[84:87], v[24:27]
    ds_read_b64 v[74:75], v10 offset:3080
    v_mfma_f32_16x16x32_bf16 v[24:27], v[56:59], v[80:83], v[24:27]
    ds_read_b128 v[104:107], v11 offset:3136
    s_waitcnt lgkmcnt(9)
    v_mfma_f32_16x16x32_bf16 v[28:31], v[48:51], v[92:95], v[28:31]
    ds_read_b64 v[76:77], v10 offset:3584
    v_mfma_f32_16x16x32_bf16 v[28:31], v[52:55], v[88:91], v[28:31]
    ds_read_b64 v[78:79], v10 offset:3592
    v_mfma_f32_16x16x32_bf16 v[28:31], v[56:59], v[84:87], v[28:31]
    ds_read_b128 v[108:111], v11 offset:3648
    v_mfma_f32_16x16x32_bf16 v[28:31], v[60:63], v[80:83], v[28:31]
    s_waitcnt lgkmcnt(9)
    v_mfma_f32_16x16x32_bf16 v[32:35], v[48:51], v[96:99], v[32:35]
    ds_read_b64 v[112:113], v10 offset:64
    v_mfma_f32_16x16x32_bf16 v[32:35], v[52:55], v[92:95], v[32:35]
    ds_read_b64 v[114:115], v10 offset:72
    v_mfma_f32_16x16x32_bf16 v[32:35], v[56:59], v[88:91], v[32:35]
    ds_read_b128 v[144:147], v11 offset:0
    v_mfma_f32_16x16x32_bf16 v[32:35], v[60:63], v[84:87], v[32:35]
    v_mfma_f32_16x16x32_bf16 v[32:35], v[64:67], v[80:83], v[32:35]
    s_cmp_lg_u32 s28, 5
    s_cbranch_scc1 Ltk_25
    s_add_u32 s72, s89, 0
    buffer_load_dword v232, v234, s[52:55], s72 offen
Ltk_25:
    s_waitcnt lgkmcnt(9)
    v_mfma_f32_16x16x32_bf16 v[36:39], v[48:51], v[100:103], v[36:39]
    ds_read_b64 v[116:117], v10 offset:576
    v_mfma_f32_16x16x32_bf16 v[36:39], v[52:55], v[96:99], v[36:39]
    ds_read_b64 v[118:119], v10 offset:584
    v_mfma_f32_16x16x32_bf16 v[36:39], v[56:59], v[92:95], v[36:39]
    ds_read_b128 v[148:151], v11 offset:512
    v_mfma_f32_16x16x32_bf16 v[36:39], v[60:63], v[88:91], v[36:39]
    v_mfma_f32_16x16x32_bf16 v[36:39], v[64:67], v[84:87], v[36:39]
    v_mfma_f32_16x16x32_bf16 v[36:39], v[68:71], v[80:83], v[36:39]
    s_waitcnt lgkmcnt(9)
    v_mfma_f32_16x16x32_bf16 v[40:43], v[48:51], v[104:107], v[40:43]
    ds_read_b64 v[120:121], v10 offset:1088
    v_mfma_f32_16x16x32_bf16 v[40:43], v[52:55], v[100:103], v[40:43]
    ds_read_b64 v[122:123], v10 offset:1096
    v_mfma_f32_16x16x32_bf16 v[40:43], v[56:59], v[96:99], v[40:43]
    ds_read_b128 v[152:155], v11 offset:1024
    v_mfma_f32_16x16x32_bf16 v[40:43], v[60:63], v[92:95], v[40:43]
    v_mfma_f32_16x16x32_bf16 v[40:43], v[64:67], v[88:91], v[40:43]
    v_mfma_f32_16x16x32_bf16 v[40:43], v[68:71], v[84:87], v[40:43]
    v_mfma_f32_16x16x32_bf16 v[40:43], v[72:75], v[80:83], v[40:43]
    s_waitcnt lgkmcnt(9)
    v_mfma_f32_16x16x32_bf16 v[44:47], v[48:51], v[108:111], v[44:47]
    ds_read_b64 v[124:125], v10 offset:1600
    v_mfma_f32_16x16x32_bf16 v[44:47], v[52:55], v[104:107], v[44:47]
    ds_read_b64 v[126:127], v10 offset:1608
    v_mfma_f32_16x16x32_bf16 v[44:47], v[56:59], v[100:103], v[44:47]
    ds_read_b128 v[156:159], v11 offset:1536
    v_mfma_f32_16x16x32_bf16 v[44:47], v[60:63], v[96:99], v[44:47]
    v_mfma_f32_16x16x32_bf16 v[44:47], v[64:67], v[92:95], v[44:47]
    v_mfma_f32_16x16x32_bf16 v[44:47], v[68:71], v[88:91], v[44:47]
    v_mfma_f32_16x16x32_bf16 v[44:47], v[72:75], v[84:87], v[44:47]
    v_mfma_f32_16x16x32_bf16 v[44:47], v[76:79], v[80:83], v[44:47]
    s_cmp_lg_u32 s28, 6
    s_cbranch_scc1 Ltk_26
    s_add_u32 s72, s89, 0
    buffer_load_dword v232, v234, s[52:55], s72 offen
Ltk_26:
    s_waitcnt lgkmcnt(9)
    v_mfma_f32_16x16x32_bf16 v[16:19], v[112:115], v[144:147], v[16:19]
    ds_read_b64 v[128:129], v10 offset:2112
    s_waitcnt lgkmcnt(7)
    v_mfma_f32_16x16x32_bf16 v[20:23], v[112:115], v[148:151], v[20:23]
    ds_read_b64 v[130:131], v10 offset:2120
    v_mfma_f32_16x16x32_bf16 v[20:23], v[116:119], v[144:147], v[20:23]
    ds_read_b128 v[160:163], v11 offset:2048
    s_waitcnt lgkmcnt(6)
    v_mfma_f32_16x16x32_bf16 v[24:27], v[112:115], v[152:155], v[24:27]
    ds_read_b64 v[132:133], v10 offset:2624
    v_mfma_f32_16x16x32_bf16 v[24:27], v[116:119], v[148:151], v[24:27]
    ds_read_b64 v[134:135], v10 offset:2632
    v_mfma_f32_16x16x32_bf16 v[24:27], v[120:123], v[144:147], v[24:27]
    ds_read_b128 v[164:167], v11 offset:2560
    s_waitcnt lgkmcnt(6)
    v_mfma_f32_16x16x32_bf16 v[28:31], v[112:115], v[156:159], v[28:31]
    ds_read_b64 v[136:137], v10 offset:3136
    v_mfma_f32_16x16x32_bf16 v[28:31], v[116:119], v[152:155], v[28:31]
    ds_read_b64 v[138:139], v10 offset:3144
    v_mfma_f32_16x16x32_bf16 v[28:31], v[120:123], v[148:151], v[28:31]
    ds_read_b128 v[168:171], v11 offset:3072
    v_mfma_f32_16x16x32_bf16 v[28:31], v[124:127], v[144:147], v[28:31]
    s_waitcnt lgkmcnt(6)
    v_mfma_f32_16x16x32_bf16 v[32:35], v[112:115], v[160:163], v[32:35]
    ds_read_b64 v[140:141], v10 offset:3648
    v_mfma_f32_16x16x32_bf16 v[32:35], v[116:119], v[156:159], v[32:35]
    ds_read_b64 v[142:143], v10 offset:3656
    v_mfma_f32_16x16x32_bf16 v[32:35], v[120:123], v[152:155], v[32:35]
    ds_read_b128 v[172:175], v11 offset:3584
    v_mfma_f32_16x16x32_bf16 v[32:35], v[124:127], v[148:151], v[32:35]
    v_mfma_f32_16x16x32_bf16 v[32:35], v[128:131], v[144:147], v[32:35]
    s_waitcnt lgkmcnt(6)
    v_mfma_f32_16x16x32_bf16 v[36:39], v[112:115], v[164:167], v[36:39]
    v_mfma_f32_16x16x32_bf16 v[36:39], v[116:119], v[160:163], v[36:39]
    v_mfma_f32_16x16x32_bf16 v[36:39], v[120:123], v[156:159], v[36:39]
    v_mfma_f32_16x16x32_bf16 v[36:39], v[124:127], v[152:155], v[36:39]
    v_mfma_f32_16x16x32_bf16 v[36:39], v[128:131], v[148:151], v[36:39]
    v_mfma_f32_16x16x32_bf16 v[36:39], v[132:135], v[144:147], v[36:39]
    s_waitcnt lgkmcnt(3)
    v_mfma_f32_16x16x32_bf16 v[40:43], v[112:115], v[168:171], v[40:43]
    v_mfma_f32_16x16x32_bf16 v[40:43], v[116:119], v[164:167], v[40:43]
    v_mfma_f32_16x16x32_bf16 v[40:43], v[120:123], v[160:163], v[40:43]
    v_mfma_f32_16x16x32_bf16 v[40:43], v[124:127], v[156:159], v[40:43]
    v_mfma_f32_16x16x32_bf16 v[40:43], v[128:131], v[152:155], v[40:43]
    v_mfma_f32_16x16x32_bf16 v[40:43], v[132:135], v[148:151], v[40:43]
    v_mfma_f32_16x16x32_bf16 v[40:43], v[136:139], v[144:147], v[40:43]
    s_waitcnt lgkmcnt(0)
    v_mfma_f32_16x16x32_bf16 v[44:47], v[112:115], v[172:175], v[44:47]
    v_mfma_f32_16x16x32_bf16 v[44:47], v[116:119], v[168:171], v[44:47]
    v_mfma_f32_16x16x32_bf16 v[44:47], v[120:123], v[164:167], v[44:47]
    v_mfma_f32_16x16x32_bf16 v[44:47], v[124:127], v[160:163], v[44:47]
    v_mfma_f32_16x16x32_bf16 v[44:47], v[128:131], v[156:159], v[44:47]
    v_mfma_f32_16x16x32_bf16 v[44:47], v[132:135], v[152:155], v[44:47]
    v_mfma_f32_16x16x32_bf16 v[44:47], v[136:139], v[148:151], v[44:47]
    v_mfma_f32_16x16x32_bf16 v[44:47], v[140:143], v[144:147], v[44:47]
    s_add_u32 s72, s28, 1
    s_and_b32 s72, s72, 7
    s_cmp_gt_u32 s72, 1
    s_cbranch_scc1 L_conv_red
    s_mov_b32 s75, 0x05040100
    s_mov_b32 s76, 0x07060302
    s_mov_b32 s90, 10485760
    s_mov_b32 s91, 10486784
    s_waitcnt vmcnt(0)
    v_perm_b32 v216, v193, v192, s75
    v_perm_b32 v217, v195, v194, s75
    v_perm_b32 v218, v197, v196, s75
    v_perm_b32 v219, v199, v198, s75
    v_perm_b32 v220, v193, v192, s76
    v_perm_b32 v221, v195, v194, s76
    v_perm_b32 v222, v197, v196, s76
    v_perm_b32 v223, v199, v198, s76
    buffer_store_dwordx4 v[216:219], v214, s[68:71], s90 offen sc1
    buffer_store_dwordx4 v[220:223], v214, s[68:71], s91 offen sc1
    s_cmp_eq_u32 s95, 0
    s_cbranch_scc1 L_conv_red
    v_perm_b32 v224, v201, v200, s75
    v_perm_b32 v225, v203, v202, s75
    v_perm_b32 v226, v205, v204, s75
    v_perm_b32 v227, v207, v206, s75
    v_perm_b32 v228, v201, v200, s76
    v_perm_b32 v229, v203, v202, s76
    v_perm_b32 v230, v205, v204, s76
    v_perm_b32 v231, v207, v206, s76
    buffer_store_dwordx4 v[224:227], v215, s[68:71], s90 offen sc1
    buffer_store_dwordx4 v[228:231], v215, s[68:71], s91 offen sc1
L_conv_red:
    s_lshl_b32 s72, s28, 13
    s_add_u32 s72, s72, 28672
    v_add_u32 v184, s72, v5
    ds_write_b128 v184, v[16:19] offset:0
    ds_write_b128 v184, v[20:23] offset:1024
    ds_write_b128 v184, v[24:27] offset:2048
    ds_write_b128 v184, v[28:31] offset:3072
    ds_write_b128 v184, v[32:35] offset:4096
    ds_write_b128 v184, v[36:39] offset:5120
    ds_write_b128 v184, v[40:43] offset:6144
    s_nop 5
    ds_write_b128 v184, v[44:47] offset:7168
    s_lshl_b32 s72, s28, 10
    s_add_u32 s72, s72, 28672
    v_add_u32 v186, s72, v5
    v_lshlrev_b32 v185, 5, v2
    v_lshrrev_b32 v4, 1, v3
    v_lshl_add_u32 v185, v4, 4, v185
    v_and_b32 v4, 1, v3
    v_lshlrev_b32 v4, 3, v4
    v_sub_u32 v185, v185, v4
    s_lshl_b32 s72, s28, 9
    s_add_u32 s72, s72, 115208
    v_add_u32 v185, s72, v185
    ds_read_b64 v[176:177], v185
    ds_read_b64 v[178:179], v185 offset:4608
    s_lshl_b32 s76, s93, 16
    s_and_b32 s77, s93, 0xffff0000
    v_lshrrev_b32 v187, 1, v2
    v_lshlrev_b32 v187, 15, v187
    v_lshl_add_u32 v187, v4, 3, v187
    v_lshrrev_b32 v4, 1, v3
    v_lshl_add_u32 v187, v4, 4, v187
    v_and_b32 v4, 1, v2
    v_lshl_add_u32 v187, v4, 5, v187
    s_lshl_b32 s90, s83, 7
    s_lshl_b32 s73, s28, 18
    s_add_u32 s90, s90, s73
    s_add_u32 s90, s90, 6291456
    s_lshl_b32 s73, s28, 8
    s_add_u32 s73, s73, s83
    s_lshl_b32 s91, s73, 7
    s_add_u32 s91, s91, 21233664
    s_lshr_b32 s72, 0x89, s28
    s_and_b32 s72, s72, 1
    s_cbranch_scc0 L_nvw
    s_waitcnt vmcnt(0)
L_nvw:
    s_waitcnt lgkmcnt(0)
    s_barrier
    ds_read_b128 v[116:119], v13 offset:8192
    ds_read_b128 v[112:115], v13
    ds_read_b128 v[48:51], v186 offset:0
    ds_read_b128 v[52:55], v186 offset:8192
    ds_read_b128 v[56:59], v186 offset:16384
    ds_read_b128 v[60:63], v186 offset:24576
    ds_read_b128 v[64:67], v186 offset:32768
    ds_read_b128 v[68:71], v186 offset:40960
    ds_read_b128 v[72:75], v186 offset:49152
    ds_read_b128 v[76:79], v186 offset:57344
    v_lshlrev_b32 v126, 16, v176
    v_and_b32 v124, 0xffff0000, v176
    v_lshlrev_b32 v122, 16, v177
    v_and_b32 v120, 0xffff0000, v177
    v_lshlrev_b32 v127, 16, v178
    v_and_b32 v125, 0xffff0000, v178
    v_lshlrev_b32 v123, 16, v179
    v_and_b32 v121, 0xffff0000, v179
    s_waitcnt lgkmcnt(8)
    v_and_b32 v152, 0xffff0000, v116
    v_and_b32 v153, 0xffff0000, v117
    v_and_b32 v154, 0xffff0000, v118
    v_and_b32 v155, 0xffff0000, v119
    v_rcp_f32 v152, v152
    v_rcp_f32 v153, v153
    v_rcp_f32 v154, v154
    v_rcp_f32 v155, v155
    v_lshlrev_b32 v156, 16, v116
    v_lshlrev_b32 v128, 16, v112
    v_and_b32 v129, 0xffff0000, v112
    v_lshlrev_b32 v157, 16, v117
    v_lshlrev_b32 v130, 16, v113
    v_and_b32 v131, 0xffff0000, v113
    v_lshlrev_b32 v158, 16, v118
    v_lshlrev_b32 v132, 16, v114
    v_and_b32 v133, 0xffff0000, v114
    v_lshlrev_b32 v159, 16, v119
    v_lshlrev_b32 v134, 16, v115
    v_and_b32 v135, 0xffff0000, v115
    v_sub_f32 v136, v128, v156
    v_sub_f32 v137, v129, v156
    v_sub_f32 v138, v130, v157
    v_sub_f32 v139, v131, v157
    v_sub_f32 v140, v132, v158
    v_sub_f32 v141, v133, v158
    v_sub_f32 v142, v134, v159
    v_sub_f32 v143, v135, v159
    v_mul_f32 v136, v136, v152
    v_mul_f32 v137, v137, v152
    v_mul_f32 v138, v138, v153
    v_mul_f32 v139, v139, v153
    v_mul_f32 v140, v140, v154
    v_mul_f32 v141, v141, v154
    v_mul_f32 v142, v142, v155
    v_mul_f32 v143, v143, v155
    s_waitcnt lgkmcnt(0)
    v_pk_add_f32 v[48:49], v[48:49], v[52:53]
    v_pk_add_f32 v[56:57], v[56:57], v[60:61]
    v_pk_add_f32 v[50:51], v[50:51], v[54:55]
    v_pk_add_f32 v[58:59], v[58:59], v[62:63]
    v_add_f32 v144, v48, v56
    v_add_f32 v146, v49, v57
    v_add_f32 v148, v50, v58
    v_add_f32 v150, v51, v59
    v_pk_add_f32 v[64:65], v[64:65], v[68:69]
    v_pk_add_f32 v[72:73], v[72:73], v[76:77]
    v_pk_add_f32 v[66:67], v[66:67], v[70:71]
    v_pk_add_f32 v[74:75], v[74:75], v[78:79]
    v_add_f32 v145, v64, v72
    v_add_f32 v147, v65, v73
    v_add_f32 v149, v66, v74
    v_add_f32 v151, v67, v75
    v_pk_fma_f32 v[144:145], v[120:121], s[76:77], v[144:145]
    v_pk_fma_f32 v[146:147], v[122:123], s[76:77], v[146:147]
    v_pk_fma_f32 v[148:149], v[124:125], s[76:77], v[148:149]
    v_pk_fma_f32 v[150:151], v[126:127], s[76:77], v[150:151]
    v_pk_fma_f32 v[144:145], v[136:137], v[144:145], v[128:129]
    v_pk_fma_f32 v[146:147], v[138:139], v[146:147], v[130:131]
    v_pk_fma_f32 v[148:149], v[140:141], v[148:149], v[132:133]
    v_pk_fma_f32 v[150:151], v[142:143], v[150:151], v[134:135]
    v_cvt_pk_bf16_f32 v160, v144, v146
    v_cvt_pk_bf16_f32 v161, v148, v150
    v_cvt_pk_bf16_f32 v162, v145, v147
    v_cvt_pk_bf16_f32 v163, v149, v151
    s_nop 1
    v_permlane16_swap_b32 v160, v162
    v_permlane16_swap_b32 v161, v163
    s_nop 1
    buffer_store_dwordx4 v[160:163], v187, s[68:71], s90 offen sc1
    s_waitcnt vmcnt(0)
    v_mov_b32 v4, 0
    s_mov_b64 exec, 1
    buffer_store_dwordx2 v[6:7], v4, s[68:71], s91 offen sc1
    s_mov_b64 exec, -1
    s_barrier
    s_cmp_eq_u32 s28, 7
    s_cbranch_scc1 Lw7_27
    s_lshl_b32 s77, s28, 6
    v_add_u32 v133, s77, v1
    v_mul_u32_u24 v4, 4682, v133
    v_lshrrev_b32 v4, 16, v4
    v_lshlrev_b32 v133, 4, v133
    s_movk_i32 s77, 3360
    v_mad_u32_u24 v133, v4, s77, v133
    s_lshl_b32 s95, s28, 10
    s_add_u32 m0, s95, 0
    s_add_u32 s72, s88, 0
    buffer_load_dwordx4 v133, s[52:55], s72 offen lds
    s_add_u32 m0, s95, 7168
    s_add_u32 s72, s88, 114688
    buffer_load_dwordx4 v133, s[52:55], s72 offen lds
    s_add_u32 m0, s95, 14336
    s_add_u32 s72, s88, 229376
    buffer_load_dwordx4 v133, s[52:55], s72 offen lds
    s_add_u32 m0, s95, 21504
    s_add_u32 s72, s88, 344064
    buffer_load_dwordx4 v133, s[52:55], s72 offen lds
    s_add_u32 m0, s95, 28672
    s_add_u32 s72, s88, 458752
    buffer_load_dwordx4 v133, s[52:55], s72 offen lds
    s_add_u32 m0, s95, 35840
    s_add_u32 s72, s88, 573440
    buffer_load_dwordx4 v133, s[52:55], s72 offen lds
    s_add_u32 m0, s95, 43008
    s_add_u32 s72, s88, 688128
    buffer_load_dwordx4 v133, s[52:55], s72 offen lds
    s_add_u32 m0, s95, 50176
    s_add_u32 s72, s88, 802816
    buffer_load_dwordx4 v133, s[52:55], s72 offen lds
    s_branch Lw7d_28
Lw7_27:
    s_lshr_b32 s73, s84, 1
    s_lshl_b32 s73, s73, 15
    s_add_u32 s73, s73, 21233664
    s_mov_b64 s[4:5], -1
    s_mov_b64 s[6:7], -1
    s_mov_b64 s[8:9], -1
    s_mov_b64 s[16:17], -1
    s_mov_b32 s72, 40000
Lpn_29:
    s_mov_b64 exec, s[4:5]
    s_add_u32 s77, s73, 0
    s_cbranch_execz Lsk_32
    buffer_load_dwordx2 v[184:185], v14, s[68:71], s77 offen sc1
Lsk_32:
    s_mov_b64 exec, s[6:7]
    s_add_u32 s77, s73, 8192
    s_cbranch_execz Lsk_33
    buffer_load_dwordx2 v[186:187], v14, s[68:71], s77 offen sc1
Lsk_33:
    s_mov_b64 exec, s[8:9]
    s_add_u32 s77, s73, 16384
    s_cbranch_execz Lsk_34
    buffer_load_dwordx2 v[188:189], v14, s[68:71], s77 offen sc1
Lsk_34:
    s_mov_b64 exec, s[16:17]
    s_add_u32 s77, s73, 24576
    s_cbranch_execz Lsk_35
    buffer_load_dwordx2 v[190:191], v14, s[68:71], s77 offen sc1
Lsk_35:
    s_mov_b64 exec, -1
Lpnc_31:
    s_waitcnt vmcnt(0)
    v_cmp_ne_u64 vcc, v[184:185], v[6:7]
    s_and_b64 s[4:5], s[4:5], vcc
    v_cmp_ne_u64 vcc, v[186:187], v[6:7]
    s_and_b64 s[6:7], s[6:7], vcc
    v_cmp_ne_u64 vcc, v[188:189], v[6:7]
    s_and_b64 s[8:9], s[8:9], vcc
    v_cmp_ne_u64 vcc, v[190:191], v[6:7]
    s_and_b64 s[16:17], s[16:17], vcc
    s_mov_b64 s[10:11], s[4:5]
    s_or_b64 s[10:11], s[10:11], s[6:7]
    s_or_b64 s[10:11], s[10:11], s[8:9]
    s_or_b64 s[10:11], s[10:11], s[16:17]
    s_sub_u32 s72, s72, 1
    s_cmp_eq_u32 s72, 0
    s_cbranch_scc1 Lpnd_30
    s_cmp_eq_u64 s[10:11], 0
    s_cbranch_scc1 Lpnd_30
    s_branch Lpn_29
Lpnd_30:
Lw7d_28:
    v_lshrrev_b32 v8, 1, v3
    v_lshlrev_b32 v8, 4, v8
    v_and_b32 v4, 1, v3
    v_lshl_add_u32 v8, v4, 2, v8
    v_lshrrev_b32 v4, 2, v2
    v_add_u32 v8, v8, v4
    v_and_b32 v4, 3, v2
    v_lshlrev_b32 v4, 3, v4
    v_and_b32 v9, 7, v8
    v_lshl_add_u32 v9, v9, 5, v4
    v_lshrrev_b32 v190, 1, v3
    v_lshl_add_u32 v9, v190, 10, v9
    v_lshrrev_b32 v190, 5, v1
    v_lshlrev_b32 v190, 9, v190
    v_bfe_u32 v191, v1, 1, 3
    v_lshl_add_u32 v190, v191, 6, v190
    v_bfe_u32 v191, v1, 4, 1
    v_lshl_add_u32 v190, v191, 5, v190
    v_and_b32 v191, 1, v1
    v_lshl_add_u32 v190, v191, 4, v190
    v_mul_u32_u24 v8, 224, v8
    v_add_u32 v8, v8, v4
    s_mul_i32 s92, s79, 12288
    s_add_u32 s92, s92, 114688
    v_add_u32 v9, s92, v9
    s_lshl_b32 s72, s94, 5
    s_lshl_b32 s73, s78, 7
    s_add_u32 s72, s72, s73
    v_add_u32 v10, s72, v8
    v_add_u32 v11, 57344, v10
    s_mul_i32 s73, s94, 192
    s_sub_u32 s73, 192, s73
    v_add_u32 v12, s73, v8
    v_add_u32 v13, 57344, v12
    s_add_u32 s72, s28, s94
    s_lshl_b32 s72, s72, 5
    s_cmp_eq_u32 s28, 6
    s_cselect_b32 s72, s73, s72
    v_add_u32 v188, s72, v8
    v_add_u32 v189, 57344, v188
    s_lshl_b32 s90, s84, 3
    s_lshl_b32 s72, s79, 1
    s_add_u32 s90, s90, s72
    s_lshl_b32 s91, s90, 14
    s_add_u32 s91, s91, 6291456
    v_mov_b32 v16, 0
    v_mov_b32 v17, 0
    v_mov_b32 v18, 0
    v_mov_b32 v19, 0
    v_mov_b32 v20, 0
    v_mov_b32 v21, 0
    v_mov_b32 v22, 0
    v_mov_b32 v23, 0
    v_mov_b32 v24, 0
    v_mov_b32 v25, 0
    v_mov_b32 v26, 0
    v_mov_b32 v27, 0
    v_mov_b32 v28, 0
    v_mov_b32 v29, 0
    v_mov_b32 v30, 0
    v_mov_b32 v31, 0
    v_mov_b32 v32, 0
    v_mov_b32 v33, 0
    v_mov_b32 v34, 0
    v_mov_b32 v35, 0
    v_mov_b32 v36, 0
    v_mov_b32 v37, 0
    v_mov_b32 v38, 0
    v_mov_b32 v39, 0
    v_mov_b32 v40, 0
    v_mov_b32 v41, 0
    v_mov_b32 v42, 0
    v_mov_b32 v43, 0
    v_mov_b32 v44, 0
    v_mov_b32 v45, 0
    v_mov_b32 v46, 0
    v_mov_b32 v47, 0
    v_mov_b32 v48, 0
    v_mov_b32 v49, 0
    v_mov_b32 v50, 0
    v_mov_b32 v51, 0
    v_mov_b32 v52, 0
    v_mov_b32 v53, 0
    v_mov_b32 v54, 0
    v_mov_b32 v55, 0
    v_mov_b32 v56, 0x3f803f80
    v_mov_b32 v57, 0x3f803f80
    v_mov_b32 v58, 0x3f803f80
    v_mov_b32 v59, 0x3f803f80
    s_waitcnt vmcnt(0)
    s_barrier
    s_lshl_b32 s73, s84, 17
    s_and_b32 s72, s30, 7
    s_lshl_b32 s72, s72, 14
    s_add_u32 s73, s73, s72
    s_and_b32 s72, s28, 1
    s_lshl_b32 s72, s72, 13
    s_add_u32 s73, s73, s72
    s_add_u32 s73, s73, 6291456
    s_cmp_lt_u32 s28, 6
    s_cbranch_scc1 L_noht
    buffer_load_dword v135, v14, s[68:71], s73 offen
L_noht:
    s_mul_i32 s89, s30, 28672
    s_lshl_b32 s72, s79, 13
    s_min_u32 s72, s72, 20480
    s_add_u32 s89, s89, s72
    s_and_b32 s72, s29, 1
    s_mul_i32 s72, s72, 917504
    s_add_u32 s89, s89, s72
    s_add_u32 s89, s89, 10485760
    s_cmp_eq_u32 s78, 1
    s_cbranch_scc1 L_nohp
    s_add_u32 m0, s92, 0
    s_add_u32 s74, s91, 0
    buffer_load_dwordx4 v190, s[68:71], s74 offen sc1 lds
    buffer_load_dwordx4 v190, s[68:71], s74 offen offset:1024 sc1 lds
    s_add_u32 m0, s92, 2048
    s_add_u32 s74, s91, 2048
    buffer_load_dwordx4 v190, s[68:71], s74 offen sc1 lds
    buffer_load_dwordx4 v190, s[68:71], s74 offen offset:1024 sc1 lds
    s_add_u32 m0, s92, 4096
    s_add_u32 s74, s91, 4096
    buffer_load_dwordx4 v190, s[68:71], s74 offen sc1 lds
    buffer_load_dwordx4 v190, s[68:71], s74 offen offset:1024 sc1 lds
    s_add_u32 m0, s92, 6144
    s_add_u32 s74, s91, 6144
    buffer_load_dwordx4 v190, s[68:71], s74 offen sc1 lds
    buffer_load_dwordx4 v190, s[68:71], s74 offen offset:1024 sc1 lds
    s_add_u32 m0, s92, 8192
    s_add_u32 s74, s91, 8192
    buffer_load_dwordx4 v190, s[68:71], s74 offen sc1 lds
    buffer_load_dwordx4 v190, s[68:71], s74 offen offset:1024 sc1 lds
    s_add_u32 m0, s92, 10240
    s_add_u32 s74, s91, 10240
    buffer_load_dwordx4 v190, s[68:71], s74 offen sc1 lds
    buffer_load_dwordx4 v190, s[68:71], s74 offen offset:1024 sc1 lds
L_nohp:
    s_cmp_eq_u32 s28, 7
    s_cbranch_scc1 Lcs_36
    ds_read_b64_tr_b16 v[80:81], v188 offset:0
    ds_read_b64_tr_b16 v[82:83], v188 offset:1792
    ds_read_b64_tr_b16 v[84:85], v188 offset:7168
    ds_read_b64_tr_b16 v[86:87], v188 offset:8960
    ds_read_b64_tr_b16 v[88:89], v188 offset:14336
    ds_read_b64_tr_b16 v[90:91], v188 offset:16128
    ds_read_b64_tr_b16 v[92:93], v188 offset:21504
    ds_read_b64_tr_b16 v[94:95], v188 offset:23296
    ds_read_b64_tr_b16 v[96:97], v188 offset:28672
    ds_read_b64_tr_b16 v[98:99], v188 offset:30464
    ds_read_b64_tr_b16 v[100:101], v188 offset:35840
    ds_read_b64_tr_b16 v[102:103], v188 offset:37632
    ds_read_b64_tr_b16 v[104:105], v188 offset:43008
    ds_read_b64_tr_b16 v[106:107], v188 offset:44800
    s_waitcnt lgkmcnt(12)
    v_mfma_f32_16x16x32_bf16 v[60:63], v[80:83], v[56:59], 0
    ds_read_b64_tr_b16 v[80:81], v188 offset:50176
    ds_read_b64_tr_b16 v[82:83], v188 offset:51968
    s_waitcnt lgkmcnt(12)
    v_mfma_f32_16x16x32_bf16 v[60:63], v[84:87], v[56:59], v[60:63]
    s_waitcnt lgkmcnt(10)
    v_mfma_f32_16x16x32_bf16 v[60:63], v[88:91], v[56:59], v[60:63]
    s_waitcnt lgkmcnt(8)
    v_mfma_f32_16x16x32_bf16 v[60:63], v[92:95], v[56:59], v[60:63]
    s_waitcnt lgkmcnt(6)
    v_mfma_f32_16x16x32_bf16 v[60:63], v[96:99], v[56:59], v[60:63]
    s_waitcnt lgkmcnt(4)
    v_mfma_f32_16x16x32_bf16 v[60:63], v[100:103], v[56:59], v[60:63]
    s_waitcnt lgkmcnt(2)
    v_mfma_f32_16x16x32_bf16 v[60:63], v[104:107], v[56:59], v[60:63]
    s_waitcnt lgkmcnt(0)
    v_mfma_f32_16x16x32_bf16 v[60:63], v[80:83], v[56:59], v[60:63]
Lcs_36:
    s_cmp_eq_u32 s78, 1
    s_cbranch_scc1 L_g1_b
    ds_read_b64_tr_b16 v[80:81], v10 offset:0
    ds_read_b64_tr_b16 v[82:83], v10 offset:1792
    ds_read_b64_tr_b16 v[84:85], v10 offset:32
    ds_read_b64_tr_b16 v[86:87], v10 offset:1824
    ds_read_b64_tr_b16 v[88:89], v10 offset:64
    ds_read_b64_tr_b16 v[90:91], v10 offset:1856
    ds_read_b64_tr_b16 v[92:93], v10 offset:96
    ds_read_b64_tr_b16 v[94:95], v10 offset:1888
    s_waitcnt vmcnt(8)
    s_barrier
    ds_read_b64_tr_b16 v[64:65], v9 offset:0
    ds_read_b64_tr_b16 v[66:67], v9 offset:512
    ds_read_b64_tr_b16 v[68:69], v9 offset:256
    ds_read_b64_tr_b16 v[70:71], v9 offset:768
    s_waitcnt lgkmcnt(0)
    v_mfma_f32_16x16x32_bf16 v[16:19], v[80:83], v[64:67], v[16:19]
    ds_read_b64_tr_b16 v[72:73], v9 offset:2048
    ds_read_b64_tr_b16 v[74:75], v9 offset:2560
    v_mfma_f32_16x16x32_bf16 v[20:23], v[80:83], v[68:71], v[20:23]
    ds_read_b64_tr_b16 v[76:77], v9 offset:2304
    ds_read_b64_tr_b16 v[78:79], v9 offset:2816
    v_mfma_f32_16x16x32_bf16 v[24:27], v[84:87], v[64:67], v[24:27]
    ds_read_b64_tr_b16 v[96:97], v10 offset:7168
    ds_read_b64_tr_b16 v[98:99], v10 offset:8960
    v_mfma_f32_16x16x32_bf16 v[28:31], v[84:87], v[68:71], v[28:31]
    ds_read_b64_tr_b16 v[100:101], v10 offset:7200
    ds_read_b64_tr_b16 v[102:103], v10 offset:8992
    v_mfma_f32_16x16x32_bf16 v[32:35], v[88:91], v[64:67], v[32:35]
    ds_read_b64_tr_b16 v[104:105], v10 offset:7232
    ds_read_b64_tr_b16 v[106:107], v10 offset:9024
    v_mfma_f32_16x16x32_bf16 v[36:39], v[88:91], v[68:71], v[36:39]
    ds_read_b64_tr_b16 v[108:109], v10 offset:7264
    ds_read_b64_tr_b16 v[110:111], v10 offset:9056
    v_mfma_f32_16x16x32_bf16 v[40:43], v[92:95], v[64:67], v[40:43]
    s_add_u32 m0, s95, 57344
    s_add_u32 s72, s88, 917504
    buffer_load_dwordx4 v133, s[52:55], s72 offen lds
    s_add_u32 m0, s95, 64512
    s_add_u32 s72, s88, 1032192
    buffer_load_dwordx4 v133, s[52:55], s72 offen lds
    v_mfma_f32_16x16x32_bf16 v[44:47], v[92:95], v[68:71], v[44:47]
    s_waitcnt lgkmcnt(0)
    v_mfma_f32_16x16x32_bf16 v[16:19], v[96:99], v[72:75], v[16:19]
    s_waitcnt vmcnt(6)
    s_barrier
    s_add_u32 m0, s92, 0
    s_add_u32 s74, s91, 12288
    buffer_load_dwordx4 v190, s[68:71], s74 offen sc1 lds
    buffer_load_dwordx4 v190, s[68:71], s74 offen offset:1024 sc1 lds
    v_mfma_f32_16x16x32_bf16 v[20:23], v[96:99], v[76:79], v[20:23]
    s_add_u32 m0, s92, 2048
    s_add_u32 s74, s91, 14336
    buffer_load_dwordx4 v190, s[68:71], s74 offen sc1 lds
    buffer_load_dwordx4 v190, s[68:71], s74 offen offset:1024 sc1 lds
    ds_read_b64_tr_b16 v[64:65], v9 offset:4096
    ds_read_b64_tr_b16 v[66:67], v9 offset:4608
    v_mfma_f32_16x16x32_bf16 v[24:27], v[100:103], v[72:75], v[24:27]
    ds_read_b64_tr_b16 v[68:69], v9 offset:4352
    ds_read_b64_tr_b16 v[70:71], v9 offset:4864
    ds_read_b64_tr_b16 v[80:81], v10 offset:14336
    v_mfma_f32_16x16x32_bf16 v[28:31], v[100:103], v[76:79], v[28:31]
    ds_read_b64_tr_b16 v[82:83], v10 offset:16128
    ds_read_b64_tr_b16 v[84:85], v10 offset:14368
    ds_read_b64_tr_b16 v[86:87], v10 offset:16160
    v_mfma_f32_16x16x32_bf16 v[32:35], v[104:107], v[72:75], v[32:35]
    ds_read_b64_tr_b16 v[88:89], v10 offset:14400
    ds_read_b64_tr_b16 v[90:91], v10 offset:16192
    ds_read_b64_tr_b16 v[92:93], v10 offset:14432
    v_mfma_f32_16x16x32_bf16 v[36:39], v[104:107], v[76:79], v[36:39]
    ds_read_b64_tr_b16 v[94:95], v10 offset:16224
    s_add_u32 m0, s95, 71680
    s_add_u32 s72, s88, 1146880
    buffer_load_dwordx4 v133, s[52:55], s72 offen lds
    s_add_u32 m0, s95, 78848
    s_add_u32 s72, s88, 1261568
    buffer_load_dwordx4 v133, s[52:55], s72 offen lds
    v_mfma_f32_16x16x32_bf16 v[40:43], v[108:111], v[72:75], v[40:43]
    v_mfma_f32_16x16x32_bf16 v[44:47], v[108:111], v[76:79], v[44:47]
    s_waitcnt lgkmcnt(0)
    v_mfma_f32_16x16x32_bf16 v[16:19], v[80:83], v[64:67], v[16:19]
    ds_read_b64_tr_b16 v[72:73], v9 offset:6144
    ds_read_b64_tr_b16 v[74:75], v9 offset:6656
    v_mfma_f32_16x16x32_bf16 v[20:23], v[80:83], v[68:71], v[20:23]
    ds_read_b64_tr_b16 v[76:77], v9 offset:6400
    ds_read_b64_tr_b16 v[78:79], v9 offset:6912
    v_mfma_f32_16x16x32_bf16 v[24:27], v[84:87], v[64:67], v[24:27]
    ds_read_b64_tr_b16 v[96:97], v10 offset:21504
    ds_read_b64_tr_b16 v[98:99], v10 offset:23296
    v_mfma_f32_16x16x32_bf16 v[28:31], v[84:87], v[68:71], v[28:31]
    ds_read_b64_tr_b16 v[100:101], v10 offset:21536
    ds_read_b64_tr_b16 v[102:103], v10 offset:23328
    v_mfma_f32_16x16x32_bf16 v[32:35], v[88:91], v[64:67], v[32:35]
    ds_read_b64_tr_b16 v[104:105], v10 offset:21568
    ds_read_b64_tr_b16 v[106:107], v10 offset:23360
    v_mfma_f32_16x16x32_bf16 v[36:39], v[88:91], v[68:71], v[36:39]
    ds_read_b64_tr_b16 v[108:109], v10 offset:21600
    ds_read_b64_tr_b16 v[110:111], v10 offset:23392
    v_mfma_f32_16x16x32_bf16 v[40:43], v[92:95], v[64:67], v[40:43]
    s_add_u32 m0, s95, 86016
    s_add_u32 s72, s88, 1376256
    buffer_load_dwordx4 v133, s[52:55], s72 offen lds
    s_add_u32 m0, s95, 93184
    s_add_u32 s72, s88, 1490944
    buffer_load_dwordx4 v133, s[52:55], s72 offen lds
    v_mfma_f32_16x16x32_bf16 v[44:47], v[92:95], v[68:71], v[44:47]
    s_waitcnt lgkmcnt(0)
    v_mfma_f32_16x16x32_bf16 v[16:19], v[96:99], v[72:75], v[16:19]
    s_waitcnt vmcnt(10)
    s_barrier
    s_add_u32 m0, s92, 4096
    s_add_u32 s74, s91, 16384
    buffer_load_dwordx4 v190, s[68:71], s74 offen sc1 lds
    buffer_load_dwordx4 v190, s[68:71], s74 offen offset:1024 sc1 lds
    v_mfma_f32_16x16x32_bf16 v[20:23], v[96:99], v[76:79], v[20:23]
    s_add_u32 m0, s92, 6144
    s_add_u32 s74, s91, 18432
    buffer_load_dwordx4 v190, s[68:71], s74 offen sc1 lds
    buffer_load_dwordx4 v190, s[68:71], s74 offen offset:1024 sc1 lds
    ds_read_b64_tr_b16 v[64:65], v9 offset:8192
    ds_read_b64_tr_b16 v[66:67], v9 offset:8704
    v_mfma_f32_16x16x32_bf16 v[24:27], v[100:103], v[72:75], v[24:27]
    ds_read_b64_tr_b16 v[68:69], v9 offset:8448
    ds_read_b64_tr_b16 v[70:71], v9 offset:8960
    ds_read_b64_tr_b16 v[80:81], v10 offset:28672
    v_mfma_f32_16x16x32_bf16 v[28:31], v[100:103], v[76:79], v[28:31]
    ds_read_b64_tr_b16 v[82:83], v10 offset:30464
    ds_read_b64_tr_b16 v[84:85], v10 offset:28704
    ds_read_b64_tr_b16 v[86:87], v10 offset:30496
    v_mfma_f32_16x16x32_bf16 v[32:35], v[104:107], v[72:75], v[32:35]
    ds_read_b64_tr_b16 v[88:89], v10 offset:28736
    ds_read_b64_tr_b16 v[90:91], v10 offset:30528
    ds_read_b64_tr_b16 v[92:93], v10 offset:28768
    v_mfma_f32_16x16x32_bf16 v[36:39], v[104:107], v[76:79], v[36:39]
    ds_read_b64_tr_b16 v[94:95], v10 offset:30560
    s_add_u32 m0, s95, 100352
    s_add_u32 s72, s88, 1605632
    buffer_load_dwordx4 v133, s[52:55], s72 offen lds
    s_add_u32 m0, s95, 107520
    s_add_u32 s72, s88, 1720320
    buffer_load_dwordx4 v133, s[52:55], s72 offen lds
    v_mfma_f32_16x16x32_bf16 v[40:43], v[108:111], v[72:75], v[40:43]
    v_mfma_f32_16x16x32_bf16 v[44:47], v[108:111], v[76:79], v[44:47]
    s_waitcnt lgkmcnt(0)
    v_mfma_f32_16x16x32_bf16 v[16:19], v[80:83], v[64:67], v[16:19]
    ds_read_b64_tr_b16 v[72:73], v9 offset:10240
    ds_read_b64_tr_b16 v[74:75], v9 offset:10752
    v_mfma_f32_16x16x32_bf16 v[20:23], v[80:83], v[68:71], v[20:23]
    ds_read_b64_tr_b16 v[76:77], v9 offset:10496
    ds_read_b64_tr_b16 v[78:79], v9 offset:11008
    v_mfma_f32_16x16x32_bf16 v[24:27], v[84:87], v[64:67], v[24:27]
    ds_read_b64_tr_b16 v[96:97], v10 offset:35840
    ds_read_b64_tr_b16 v[98:99], v10 offset:37632
    v_mfma_f32_16x16x32_bf16 v[28:31], v[84:87], v[68:71], v[28:31]
    ds_read_b64_tr_b16 v[100:101], v10 offset:35872
    ds_read_b64_tr_b16 v[102:103], v10 offset:37664
    v_mfma_f32_16x16x32_bf16 v[32:35], v[88:91], v[64:67], v[32:35]
    ds_read_b64_tr_b16 v[104:105], v10 offset:35904
    ds_read_b64_tr_b16 v[106:107], v10 offset:37696
    v_mfma_f32_16x16x32_bf16 v[36:39], v[88:91], v[68:71], v[36:39]
    ds_read_b64_tr_b16 v[108:109], v10 offset:35936
    ds_read_b64_tr_b16 v[110:111], v10 offset:37728
    v_mfma_f32_16x16x32_bf16 v[40:43], v[92:95], v[64:67], v[40:43]
    v_mfma_f32_16x16x32_bf16 v[44:47], v[92:95], v[68:71], v[44:47]
    s_waitcnt lgkmcnt(0)
    v_mfma_f32_16x16x32_bf16 v[16:19], v[96:99], v[72:75], v[16:19]
    s_waitcnt vmcnt(10)
    s_barrier
    v_mfma_f32_16x16x32_bf16 v[20:23], v[96:99], v[76:79], v[20:23]
    s_add_u32 m0, s92, 8192
    s_add_u32 s74, s91, 20480
    buffer_load_dwordx4 v190, s[68:71], s74 offen sc1 lds
    buffer_load_dwordx4 v190, s[68:71], s74 offen offset:1024 sc1 lds
    s_add_u32 m0, s92, 10240
    s_add_u32 s74, s91, 22528
    buffer_load_dwordx4 v190, s[68:71], s74 offen sc1 lds
    buffer_load_dwordx4 v190, s[68:71], s74 offen offset:1024 sc1 lds
    v_mfma_f32_16x16x32_bf16 v[24:27], v[100:103], v[72:75], v[24:27]
    ds_read_b64_tr_b16 v[64:65], v9 offset:0
    ds_read_b64_tr_b16 v[66:67], v9 offset:512
    v_mfma_f32_16x16x32_bf16 v[28:31], v[100:103], v[76:79], v[28:31]
    ds_read_b64_tr_b16 v[68:69], v9 offset:256
    ds_read_b64_tr_b16 v[70:71], v9 offset:768
    v_mfma_f32_16x16x32_bf16 v[32:35], v[104:107], v[72:75], v[32:35]
    ds_read_b64_tr_b16 v[80:81], v10 offset:43008
    ds_read_b64_tr_b16 v[82:83], v10 offset:44800
    v_mfma_f32_16x16x32_bf16 v[36:39], v[104:107], v[76:79], v[36:39]
    ds_read_b64_tr_b16 v[84:85], v10 offset:43040
    ds_read_b64_tr_b16 v[86:87], v10 offset:44832
    v_mfma_f32_16x16x32_bf16 v[40:43], v[108:111], v[72:75], v[40:43]
    ds_read_b64_tr_b16 v[88:89], v10 offset:43072
    ds_read_b64_tr_b16 v[90:91], v10 offset:44864
    v_mfma_f32_16x16x32_bf16 v[44:47], v[108:111], v[76:79], v[44:47]
    ds_read_b64_tr_b16 v[92:93], v10 offset:43104
    ds_read_b64_tr_b16 v[94:95], v10 offset:44896
    s_waitcnt lgkmcnt(0)
    v_mfma_f32_16x16x32_bf16 v[16:19], v[80:83], v[64:67], v[16:19]
    ds_read_b64_tr_b16 v[72:73], v9 offset:2048
    ds_read_b64_tr_b16 v[74:75], v9 offset:2560
    v_mfma_f32_16x16x32_bf16 v[20:23], v[80:83], v[68:71], v[20:23]
    ds_read_b64_tr_b16 v[76:77], v9 offset:2304
    ds_read_b64_tr_b16 v[78:79], v9 offset:2816
    v_mfma_f32_16x16x32_bf16 v[24:27], v[84:87], v[64:67], v[24:27]
    ds_read_b64_tr_b16 v[96:97], v10 offset:50176
    ds_read_b64_tr_b16 v[98:99], v10 offset:51968
    v_mfma_f32_16x16x32_bf16 v[28:31], v[84:87], v[68:71], v[28:31]
    ds_read_b64_tr_b16 v[100:101], v10 offset:50208
    ds_read_b64_tr_b16 v[102:103], v10 offset:52000
    v_mfma_f32_16x16x32_bf16 v[32:35], v[88:91], v[64:67], v[32:35]
    ds_read_b64_tr_b16 v[104:105], v10 offset:50240
    ds_read_b64_tr_b16 v[106:107], v10 offset:52032
    v_mfma_f32_16x16x32_bf16 v[36:39], v[88:91], v[68:71], v[36:39]
    ds_read_b64_tr_b16 v[108:109], v10 offset:50272
    ds_read_b64_tr_b16 v[110:111], v10 offset:52064
    v_mfma_f32_16x16x32_bf16 v[40:43], v[92:95], v[64:67], v[40:43]
    v_mfma_f32_16x16x32_bf16 v[44:47], v[92:95], v[68:71], v[44:47]
    s_waitcnt lgkmcnt(0)
    v_mfma_f32_16x16x32_bf16 v[16:19], v[96:99], v[72:75], v[16:19]
    s_waitcnt vmcnt(6)
    s_waitcnt vmcnt(18)
    s_barrier
    v_mfma_f32_16x16x32_bf16 v[20:23], v[96:99], v[76:79], v[20:23]
    s_add_u32 m0, s92, 0
    s_add_u32 s74, s91, 24576
    buffer_load_dwordx4 v190, s[68:71], s74 offen sc1 lds
    buffer_load_dwordx4 v190, s[68:71], s74 offen offset:1024 sc1 lds
    s_add_u32 m0, s92, 2048
    s_add_u32 s74, s91, 26624
    buffer_load_dwordx4 v190, s[68:71], s74 offen sc1 lds
    buffer_load_dwordx4 v190, s[68:71], s74 offen offset:1024 sc1 lds
    ds_read_b64_tr_b16 v[64:65], v9 offset:4096
    v_mfma_f32_16x16x32_bf16 v[24:27], v[100:103], v[72:75], v[24:27]
    ds_read_b64_tr_b16 v[66:67], v9 offset:4608
    ds_read_b64_tr_b16 v[68:69], v9 offset:4352
    ds_read_b64_tr_b16 v[70:71], v9 offset:4864
    v_mfma_f32_16x16x32_bf16 v[28:31], v[100:103], v[76:79], v[28:31]
    ds_read_b64_tr_b16 v[80:81], v11 offset:0
    ds_read_b64_tr_b16 v[82:83], v11 offset:1792
    ds_read_b64_tr_b16 v[84:85], v11 offset:32
    v_mfma_f32_16x16x32_bf16 v[32:35], v[104:107], v[72:75], v[32:35]
    ds_read_b64_tr_b16 v[86:87], v11 offset:1824
    ds_read_b64_tr_b16 v[88:89], v11 offset:64
    ds_read_b64_tr_b16 v[90:91], v11 offset:1856
    v_mfma_f32_16x16x32_bf16 v[36:39], v[104:107], v[76:79], v[36:39]
    ds_read_b64_tr_b16 v[92:93], v11 offset:96
    ds_read_b64_tr_b16 v[94:95], v11 offset:1888
    ds_read_b64_tr_b16 v[112:113], v189 offset:0
    v_mfma_f32_16x16x32_bf16 v[40:43], v[108:111], v[72:75], v[40:43]
    ds_read_b64_tr_b16 v[114:115], v189 offset:1792
    v_mfma_f32_16x16x32_bf16 v[44:47], v[108:111], v[76:79], v[44:47]
    s_waitcnt lgkmcnt(0)
    v_mfma_f32_16x16x32_bf16 v[16:19], v[80:83], v[64:67], v[16:19]
    ds_read_b64_tr_b16 v[72:73], v9 offset:6144
    ds_read_b64_tr_b16 v[74:75], v9 offset:6656
    v_mfma_f32_16x16x32_bf16 v[20:23], v[80:83], v[68:71], v[20:23]
    ds_read_b64_tr_b16 v[76:77], v9 offset:6400
    ds_read_b64_tr_b16 v[78:79], v9 offset:6912
    v_mfma_f32_16x16x32_bf16 v[24:27], v[84:87], v[64:67], v[24:27]
    ds_read_b64_tr_b16 v[96:97], v11 offset:7168
    ds_read_b64_tr_b16 v[98:99], v11 offset:8960
    v_mfma_f32_16x16x32_bf16 v[28:31], v[84:87], v[68:71], v[28:31]
    ds_read_b64_tr_b16 v[100:101], v11 offset:7200
    ds_read_b64_tr_b16 v[102:103], v11 offset:8992
    v_mfma_f32_16x16x32_bf16 v[32:35], v[88:91], v[64:67], v[32:35]
    ds_read_b64_tr_b16 v[104:105], v11 offset:7232
    ds_read_b64_tr_b16 v[106:107], v11 offset:9024
    v_mfma_f32_16x16x32_bf16 v[36:39], v[88:91], v[68:71], v[36:39]
    ds_read_b64_tr_b16 v[108:109], v11 offset:7264
    ds_read_b64_tr_b16 v[110:111], v11 offset:9056
    v_mfma_f32_16x16x32_bf16 v[40:43], v[92:95], v[64:67], v[40:43]
    ds_read_b64_tr_b16 v[116:117], v189 offset:7168
    ds_read_b64_tr_b16 v[118:119], v189 offset:8960
    v_mfma_f32_16x16x32_bf16 v[44:47], v[92:95], v[68:71], v[44:47]
    v_mfma_f32_16x16x32_bf16 v[60:63], v[112:115], v[56:59], v[60:63]
    s_waitcnt lgkmcnt(0)
    v_mfma_f32_16x16x32_bf16 v[16:19], v[96:99], v[72:75], v[16:19]
    s_waitcnt vmcnt(4)
    s_waitcnt vmcnt(16)
    s_barrier
    v_mfma_f32_16x16x32_bf16 v[20:23], v[96:99], v[76:79], v[20:23]
    s_add_u32 m0, s92, 4096
    s_add_u32 s74, s91, 28672
    buffer_load_dwordx4 v190, s[68:71], s74 offen sc1 lds
    buffer_load_dwordx4 v190, s[68:71], s74 offen offset:1024 sc1 lds
    s_add_u32 m0, s92, 6144
    s_add_u32 s74, s91, 30720
    buffer_load_dwordx4 v190, s[68:71], s74 offen sc1 lds
    buffer_load_dwordx4 v190, s[68:71], s74 offen offset:1024 sc1 lds
    ds_read_b64_tr_b16 v[64:65], v9 offset:8192
    v_mfma_f32_16x16x32_bf16 v[24:27], v[100:103], v[72:75], v[24:27]
    ds_read_b64_tr_b16 v[66:67], v9 offset:8704
    ds_read_b64_tr_b16 v[68:69], v9 offset:8448
    ds_read_b64_tr_b16 v[70:71], v9 offset:8960
    v_mfma_f32_16x16x32_bf16 v[28:31], v[100:103], v[76:79], v[28:31]
    ds_read_b64_tr_b16 v[80:81], v11 offset:14336
    ds_read_b64_tr_b16 v[82:83], v11 offset:16128
    ds_read_b64_tr_b16 v[84:85], v11 offset:14368
    v_mfma_f32_16x16x32_bf16 v[32:35], v[104:107], v[72:75], v[32:35]
    ds_read_b64_tr_b16 v[86:87], v11 offset:16160
    ds_read_b64_tr_b16 v[88:89], v11 offset:14400
    ds_read_b64_tr_b16 v[90:91], v11 offset:16192
    v_mfma_f32_16x16x32_bf16 v[36:39], v[104:107], v[76:79], v[36:39]
    ds_read_b64_tr_b16 v[92:93], v11 offset:14432
    ds_read_b64_tr_b16 v[94:95], v11 offset:16224
    ds_read_b64_tr_b16 v[112:113], v189 offset:14336
    v_mfma_f32_16x16x32_bf16 v[40:43], v[108:111], v[72:75], v[40:43]
    ds_read_b64_tr_b16 v[114:115], v189 offset:16128
    v_mfma_f32_16x16x32_bf16 v[44:47], v[108:111], v[76:79], v[44:47]
    v_mfma_f32_16x16x32_bf16 v[60:63], v[116:119], v[56:59], v[60:63]
    s_waitcnt lgkmcnt(0)
    v_mfma_f32_16x16x32_bf16 v[16:19], v[80:83], v[64:67], v[16:19]
    ds_read_b64_tr_b16 v[72:73], v9 offset:10240
    ds_read_b64_tr_b16 v[74:75], v9 offset:10752
    v_mfma_f32_16x16x32_bf16 v[20:23], v[80:83], v[68:71], v[20:23]
    ds_read_b64_tr_b16 v[76:77], v9 offset:10496
    ds_read_b64_tr_b16 v[78:79], v9 offset:11008
    v_mfma_f32_16x16x32_bf16 v[24:27], v[84:87], v[64:67], v[24:27]
    ds_read_b64_tr_b16 v[96:97], v11 offset:21504
    ds_read_b64_tr_b16 v[98:99], v11 offset:23296
    v_mfma_f32_16x16x32_bf16 v[28:31], v[84:87], v[68:71], v[28:31]
    ds_read_b64_tr_b16 v[100:101], v11 offset:21536
    ds_read_b64_tr_b16 v[102:103], v11 offset:23328
    v_mfma_f32_16x16x32_bf16 v[32:35], v[88:91], v[64:67], v[32:35]
    ds_read_b64_tr_b16 v[104:105], v11 offset:21568
    ds_read_b64_tr_b16 v[106:107], v11 offset:23360
    v_mfma_f32_16x16x32_bf16 v[36:39], v[88:91], v[68:71], v[36:39]
    ds_read_b64_tr_b16 v[108:109], v11 offset:21600
    ds_read_b64_tr_b16 v[110:111], v11 offset:23392
    v_mfma_f32_16x16x32_bf16 v[40:43], v[92:95], v[64:67], v[40:43]
    ds_read_b64_tr_b16 v[116:117], v189 offset:21504
    ds_read_b64_tr_b16 v[118:119], v189 offset:23296
    v_mfma_f32_16x16x32_bf16 v[44:47], v[92:95], v[68:71], v[44:47]
    s_add_u32 s74, s31, 0
    buffer_load_dwordx4 v[192:195], v5, s[68:71], s74 offen offset:0 sc1
    s_add_u32 s74, s31, 0
    buffer_load_dwordx4 v[196:199], v5, s[68:71], s74 offen offset:1024 sc1
    v_mfma_f32_16x16x32_bf16 v[60:63], v[112:115], v[56:59], v[60:63]
    s_add_u32 s74, s31, 0
    buffer_load_dwordx4 v[200:203], v5, s[68:71], s74 offen offset:2048 sc1
    s_waitcnt lgkmcnt(0)
    v_mfma_f32_16x16x32_bf16 v[16:19], v[96:99], v[72:75], v[16:19]
    s_waitcnt vmcnt(7)
    s_waitcnt vmcnt(21)
    s_barrier
    v_mfma_f32_16x16x32_bf16 v[20:23], v[96:99], v[76:79], v[20:23]
    ds_read_b64_tr_b16 v[64:65], v9 offset:0
    ds_read_b64_tr_b16 v[66:67], v9 offset:512
    ds_read_b64_tr_b16 v[68:69], v9 offset:256
    v_mfma_f32_16x16x32_bf16 v[24:27], v[100:103], v[72:75], v[24:27]
    ds_read_b64_tr_b16 v[70:71], v9 offset:768
    ds_read_b64_tr_b16 v[80:81], v11 offset:28672
    ds_read_b64_tr_b16 v[82:83], v11 offset:30464
    v_mfma_f32_16x16x32_bf16 v[28:31], v[100:103], v[76:79], v[28:31]
    ds_read_b64_tr_b16 v[84:85], v11 offset:28704
    ds_read_b64_tr_b16 v[86:87], v11 offset:30496
    ds_read_b64_tr_b16 v[88:89], v11 offset:28736
    v_mfma_f32_16x16x32_bf16 v[32:35], v[104:107], v[72:75], v[32:35]
    ds_read_b64_tr_b16 v[90:91], v11 offset:30528
    ds_read_b64_tr_b16 v[92:93], v11 offset:28768
    ds_read_b64_tr_b16 v[94:95], v11 offset:30560
    v_mfma_f32_16x16x32_bf16 v[36:39], v[104:107], v[76:79], v[36:39]
    ds_read_b64_tr_b16 v[112:113], v189 offset:28672
    ds_read_b64_tr_b16 v[114:115], v189 offset:30464
    s_add_u32 s74, s31, 0
    buffer_load_dwordx4 v[204:207], v5, s[68:71], s74 offen offset:3072 sc1
    v_mfma_f32_16x16x32_bf16 v[40:43], v[108:111], v[72:75], v[40:43]
    s_add_u32 s74, s31, 4096
    buffer_load_dwordx4 v[208:211], v5, s[68:71], s74 offen offset:0 sc1
    s_add_u32 s74, s31, 4096
    buffer_load_dwordx4 v[212:215], v5, s[68:71], s74 offen offset:1024 sc1
    v_mfma_f32_16x16x32_bf16 v[44:47], v[108:111], v[76:79], v[44:47]
    v_mfma_f32_16x16x32_bf16 v[60:63], v[116:119], v[56:59], v[60:63]
    s_waitcnt lgkmcnt(0)
    v_mfma_f32_16x16x32_bf16 v[16:19], v[80:83], v[64:67], v[16:19]
    ds_read_b64_tr_b16 v[72:73], v9 offset:2048
    ds_read_b64_tr_b16 v[74:75], v9 offset:2560
    v_mfma_f32_16x16x32_bf16 v[20:23], v[80:83], v[68:71], v[20:23]
    ds_read_b64_tr_b16 v[76:77], v9 offset:2304
    ds_read_b64_tr_b16 v[78:79], v9 offset:2816
    v_mfma_f32_16x16x32_bf16 v[24:27], v[84:87], v[64:67], v[24:27]
    ds_read_b64_tr_b16 v[96:97], v11 offset:35840
    ds_read_b64_tr_b16 v[98:99], v11 offset:37632
    v_mfma_f32_16x16x32_bf16 v[28:31], v[84:87], v[68:71], v[28:31]
    ds_read_b64_tr_b16 v[100:101], v11 offset:35872
    ds_read_b64_tr_b16 v[102:103], v11 offset:37664
    v_mfma_f32_16x16x32_bf16 v[32:35], v[88:91], v[64:67], v[32:35]
    ds_read_b64_tr_b16 v[104:105], v11 offset:35904
    ds_read_b64_tr_b16 v[106:107], v11 offset:37696
    v_mfma_f32_16x16x32_bf16 v[36:39], v[88:91], v[68:71], v[36:39]
    ds_read_b64_tr_b16 v[108:109], v11 offset:35936
    ds_read_b64_tr_b16 v[110:111], v11 offset:37728
    v_mfma_f32_16x16x32_bf16 v[40:43], v[92:95], v[64:67], v[40:43]
    ds_read_b64_tr_b16 v[116:117], v189 offset:35840
    ds_read_b64_tr_b16 v[118:119], v189 offset:37632
    v_mfma_f32_16x16x32_bf16 v[44:47], v[92:95], v[68:71], v[44:47]
    s_add_u32 s74, s31, 4096
    buffer_load_dwordx4 v[216:219], v5, s[68:71], s74 offen offset:2048 sc1
    s_add_u32 s74, s31, 4096
    buffer_load_dwordx4 v[220:223], v5, s[68:71], s74 offen offset:3072 sc1
    v_mfma_f32_16x16x32_bf16 v[60:63], v[112:115], v[56:59], v[60:63]
    s_add_u32 s74, s31, 8192
    buffer_load_dwordx4 v[224:227], v5, s[68:71], s74 offen offset:0 sc1
    s_waitcnt lgkmcnt(0)
    v_mfma_f32_16x16x32_bf16 v[16:19], v[96:99], v[72:75], v[16:19]
    s_waitcnt vmcnt(9)
    s_waitcnt vmcnt(21)
    s_barrier
    v_mfma_f32_16x16x32_bf16 v[20:23], v[96:99], v[76:79], v[20:23]
    ds_read_b64_tr_b16 v[64:65], v9 offset:4096
    ds_read_b64_tr_b16 v[66:67], v9 offset:4608
    ds_read_b64_tr_b16 v[68:69], v9 offset:4352
    v_mfma_f32_16x16x32_bf16 v[24:27], v[100:103], v[72:75], v[24:27]
    ds_read_b64_tr_b16 v[70:71], v9 offset:4864
    ds_read_b64_tr_b16 v[80:81], v11 offset:43008
    ds_read_b64_tr_b16 v[82:83], v11 offset:44800
    v_mfma_f32_16x16x32_bf16 v[28:31], v[100:103], v[76:79], v[28:31]
    ds_read_b64_tr_b16 v[84:85], v11 offset:43040
    ds_read_b64_tr_b16 v[86:87], v11 offset:44832
    ds_read_b64_tr_b16 v[88:89], v11 offset:43072
    v_mfma_f32_16x16x32_bf16 v[32:35], v[104:107], v[72:75], v[32:35]
    ds_read_b64_tr_b16 v[90:91], v11 offset:44864
    ds_read_b64_tr_b16 v[92:93], v11 offset:43104
    ds_read_b64_tr_b16 v[94:95], v11 offset:44896
    v_mfma_f32_16x16x32_bf16 v[36:39], v[104:107], v[76:79], v[36:39]
    ds_read_b64_tr_b16 v[112:113], v189 offset:43008
    ds_read_b64_tr_b16 v[114:115], v189 offset:44800
    s_add_u32 s74, s31, 8192
    buffer_load_dwordx4 v[228:231], v5, s[68:71], s74 offen offset:1024 sc1
    v_mfma_f32_16x16x32_bf16 v[40:43], v[108:111], v[72:75], v[40:43]
    s_add_u32 s74, s31, 8192
    buffer_load_dwordx4 v[232:235], v5, s[68:71], s74 offen offset:2048 sc1
    s_add_u32 s74, s31, 8192
    buffer_load_dwordx4 v[236:239], v5, s[68:71], s74 offen offset:3072 sc1
    v_mfma_f32_16x16x32_bf16 v[44:47], v[108:111], v[76:79], v[44:47]
    v_mfma_f32_16x16x32_bf16 v[60:63], v[116:119], v[56:59], v[60:63]
    s_waitcnt lgkmcnt(0)
    v_mfma_f32_16x16x32_bf16 v[16:19], v[80:83], v[64:67], v[16:19]
    ds_read_b64_tr_b16 v[72:73], v9 offset:6144
    ds_read_b64_tr_b16 v[74:75], v9 offset:6656
    v_mfma_f32_16x16x32_bf16 v[20:23], v[80:83], v[68:71], v[20:23]
    ds_read_b64_tr_b16 v[76:77], v9 offset:6400
    ds_read_b64_tr_b16 v[78:79], v9 offset:6912
    v_mfma_f32_16x16x32_bf16 v[24:27], v[84:87], v[64:67], v[24:27]
    ds_read_b64_tr_b16 v[96:97], v11 offset:50176
    ds_read_b64_tr_b16 v[98:99], v11 offset:51968
    v_mfma_f32_16x16x32_bf16 v[28:31], v[84:87], v[68:71], v[28:31]
    ds_read_b64_tr_b16 v[100:101], v11 offset:50208
    ds_read_b64_tr_b16 v[102:103], v11 offset:52000
    v_mfma_f32_16x16x32_bf16 v[32:35], v[88:91], v[64:67], v[32:35]
    ds_read_b64_tr_b16 v[104:105], v11 offset:50240
    ds_read_b64_tr_b16 v[106:107], v11 offset:52032
    v_mfma_f32_16x16x32_bf16 v[36:39], v[88:91], v[68:71], v[36:39]
    ds_read_b64_tr_b16 v[108:109], v11 offset:50272
    ds_read_b64_tr_b16 v[110:111], v11 offset:52064
    v_mfma_f32_16x16x32_bf16 v[40:43], v[92:95], v[64:67], v[40:43]
    ds_read_b64_tr_b16 v[116:117], v189 offset:50176
    ds_read_b64_tr_b16 v[118:119], v189 offset:51968
    v_mfma_f32_16x16x32_bf16 v[44:47], v[92:95], v[68:71], v[44:47]
    s_add_u32 s74, s31, 12288
    buffer_load_dwordx4 v[240:243], v5, s[68:71], s74 offen offset:0 sc1
    s_add_u32 s74, s31, 12288
    buffer_load_dwordx4 v[244:247], v5, s[68:71], s74 offen offset:1024 sc1
    v_mfma_f32_16x16x32_bf16 v[60:63], v[112:115], v[56:59], v[60:63]
    s_add_u32 s74, s31, 12288
    buffer_load_dwordx4 v[248:251], v5, s[68:71], s74 offen offset:2048 sc1
    s_waitcnt lgkmcnt(0)
    v_mfma_f32_16x16x32_bf16 v[16:19], v[96:99], v[72:75], v[16:19]
    s_add_u32 s74, s31, 12288
    buffer_load_dwordx4 v[252:255], v5, s[68:71], s74 offen offset:3072 sc1
    v_mfma_f32_16x16x32_bf16 v[20:23], v[96:99], v[76:79], v[20:23]
    s_add_u32 s74, s31, 16384
    buffer_load_dwordx4 v[136:139], v5, s[68:71], s74 offen offset:0 sc1
    v_mfma_f32_16x16x32_bf16 v[24:27], v[100:103], v[72:75], v[24:27]
    s_add_u32 s74, s31, 16384
    buffer_load_dwordx4 v[140:143], v5, s[68:71], s74 offen offset:1024 sc1
    v_mfma_f32_16x16x32_bf16 v[28:31], v[100:103], v[76:79], v[28:31]
    v_mfma_f32_16x16x32_bf16 v[32:35], v[104:107], v[72:75], v[32:35]
    v_mfma_f32_16x16x32_bf16 v[36:39], v[104:107], v[76:79], v[36:39]
    v_mfma_f32_16x16x32_bf16 v[40:43], v[108:111], v[72:75], v[40:43]
    v_mfma_f32_16x16x32_bf16 v[44:47], v[108:111], v[76:79], v[44:47]
    v_mfma_f32_16x16x32_bf16 v[60:63], v[116:119], v[56:59], v[60:63]
    s_add_u32 s74, s31, 16384
    buffer_load_dwordx4 v[144:147], v5, s[68:71], s74 offen offset:2048 sc1
    s_add_u32 s74, s31, 16384
    buffer_load_dwordx4 v[148:151], v5, s[68:71], s74 offen offset:3072 sc1
    s_add_u32 s74, s31, 20480
    buffer_load_dwordx4 v[152:155], v5, s[68:71], s74 offen offset:0 sc1
    s_add_u32 s74, s31, 20480
    buffer_load_dwordx4 v[156:159], v5, s[68:71], s74 offen offset:1024 sc1
    s_add_u32 s74, s31, 20480
    buffer_load_dwordx4 v[160:163], v5, s[68:71], s74 offen offset:2048 sc1
    s_add_u32 s74, s31, 20480
    buffer_load_dwordx4 v[164:167], v5, s[68:71], s74 offen offset:3072 sc1
    s_add_u32 s74, s31, 24576
    buffer_load_dwordx4 v[168:171], v5, s[68:71], s74 offen offset:0 sc1
    s_add_u32 s74, s31, 24576
    buffer_load_dwordx4 v[172:175], v5, s[68:71], s74 offen offset:1024 sc1
    s_add_u32 s74, s31, 24576
    buffer_load_dwordx4 v[176:179], v5, s[68:71], s74 offen offset:2048 sc1
    s_add_u32 s74, s31, 24576
    buffer_load_dwordx4 v[180:183], v5, s[68:71], s74 offen offset:3072 sc1
    s_barrier
    v_lshlrev_b32 v10, 4, v3
    s_lshl_b32 s72, s28, 6
    v_add_u32 v4, s72, v10
    s_mov_b32 exec_lo, 0x00010001
    s_mov_b32 exec_hi, 0x00010001
    ds_write_b128 v4, v[60:63] offset:0
    s_mov_b64 exec, -1
    s_lshl_b32 s72, s79, 8
    v_lshlrev_b32 v11, 3, v2
    v_add_u32 v11, s72, v11
    s_mul_i32 s72, s90, 57344
    s_add_u32 s72, s72, 12582912
    s_mul_i32 s73, s85, 7
    s_add_u32 s74, s73, s94
    s_lshr_b32 s74, s74, 1
    s_lshl_b32 s74, s74, 10
    s_add_u32 s74, s74, s72
    s_mul_i32 s75, s94, 6
    s_sub_u32 s75, 6, s75
    s_add_u32 s75, s75, s73
    s_lshr_b32 s75, s75, 1
    s_lshl_b32 s75, s75, 10
    s_add_u32 s75, s75, s72
    s_lshl_b32 s76, s94, 9
    s_add_u32 s75, s75, s76
    v_add_u32 v12, 57344, v5
    v_lshlrev_b32 v13, 3, v1
    v_add_u32 v9, 57344, v13
    s_waitcnt lgkmcnt(0)
    s_barrier
    ds_read_b64 v[64:65], v11 offset:1024
    ds_read_b64 v[66:67], v11 offset:1152
    ds_read_b128 v[80:83], v10 offset:0
    ds_read_b128 v[84:87], v10 offset:64
    ds_read_b128 v[88:91], v10 offset:128
    ds_read_b128 v[92:95], v10 offset:192
    s_waitcnt lgkmcnt(4)
    v_mul_f32 v64, 0x3b000000, v64
    v_mul_f32 v65, 0x3b000000, v65
    v_fma_f32 v65, -v64, v64, v65
    v_max_f32 v65, 0, v65
    v_cvt_pk_bf16_f32 v64, v64, v65
    v_lshlrev_b32 v70, 16, v64
    v_lshlrev_b32 v71, 16, v64
    v_and_b32 v65, 0xffff0000, v64
    v_add_f32 v65, 0x3727c5ac, v65
    v_cvt_pk_bf16_f32 v65, v65, v65
    v_and_b32 v65, 0xffff0000, v65
    v_sqrt_f32 v65, v65
    v_mul_f32 v66, 0x3b000000, v66
    v_mul_f32 v67, 0x3b000000, v67
    v_fma_f32 v67, -v66, v66, v67
    v_max_f32 v67, 0, v67
    v_cvt_pk_bf16_f32 v66, v66, v67
    v_lshlrev_b32 v74, 16, v66
    v_lshlrev_b32 v75, 16, v66
    v_and_b32 v67, 0xffff0000, v66
    v_add_f32 v67, 0x3727c5ac, v67
    v_cvt_pk_bf16_f32 v67, v67, v67
    v_and_b32 v67, 0xffff0000, v67
    v_sqrt_f32 v67, v67
    v_cvt_pk_bf16_f32 v65, v65, v65
    v_and_b32 v65, 0xffff0000, v65
    v_rcp_f32 v68, v65
    v_rcp_f32 v69, v65
    v_cvt_pk_bf16_f32 v67, v67, v67
    v_and_b32 v67, 0xffff0000, v67
    v_rcp_f32 v72, v67
    v_rcp_f32 v73, v67
    s_waitcnt lgkmcnt(0)
    v_mul_f32 v128, 0xbfb8aa3b, v68
    v_mul_f32 v129, 0xbfb8aa3b, v68
    v_mul_f32 v130, 0xbfb8aa3b, v72
    v_mul_f32 v131, 0xbfb8aa3b, v72
    v_mov_b32 v132, 1.0
    v_mov_b32 v133, 1.0
    v_pk_fma_f32 v[16:17], v[80:81], v[70:71], v[16:17] neg_lo:[0,1,0] neg_hi:[0,1,0]
    v_pk_fma_f32 v[18:19], v[82:83], v[70:71], v[18:19] neg_lo:[0,1,0] neg_hi:[0,1,0]
    v_pk_fma_f32 v[20:21], v[80:81], v[74:75], v[20:21] neg_lo:[0,1,0] neg_hi:[0,1,0]
    v_pk_fma_f32 v[22:23], v[82:83], v[74:75], v[22:23] neg_lo:[0,1,0] neg_hi:[0,1,0]
    v_pk_fma_f32 v[24:25], v[84:85], v[70:71], v[24:25] neg_lo:[0,1,0] neg_hi:[0,1,0]
    v_pk_fma_f32 v[26:27], v[86:87], v[70:71], v[26:27] neg_lo:[0,1,0] neg_hi:[0,1,0]
    v_pk_fma_f32 v[28:29], v[84:85], v[74:75], v[28:29] neg_lo:[0,1,0] neg_hi:[0,1,0]
    v_pk_fma_f32 v[30:31], v[86:87], v[74:75], v[30:31] neg_lo:[0,1,0] neg_hi:[0,1,0]
    v_pk_mul_f32 v[96:97], v[16:17], v[128:129]
    v_pk_mul_f32 v[98:99], v[18:19], v[128:129]
    v_pk_mul_f32 v[100:101], v[20:21], v[130:131]
    v_pk_mul_f32 v[102:103], v[22:23], v[130:131]
    v_pk_mul_f32 v[104:105], v[24:25], v[128:129]
    v_pk_mul_f32 v[106:107], v[26:27], v[128:129]
    v_pk_mul_f32 v[108:109], v[28:29], v[130:131]
    v_pk_mul_f32 v[110:111], v[30:31], v[130:131]
    v_exp_f32 v96, v96
    v_exp_f32 v97, v97
    v_pk_mul_f32 v[16:17], v[16:17], v[68:69]
    v_exp_f32 v98, v98
    v_exp_f32 v99, v99
    v_pk_mul_f32 v[18:19], v[18:19], v[68:69]
    v_exp_f32 v100, v100
    v_exp_f32 v101, v101
    v_pk_mul_f32 v[20:21], v[20:21], v[72:73]
    v_exp_f32 v102, v102
    v_exp_f32 v103, v103
    v_pk_mul_f32 v[22:23], v[22:23], v[72:73]
    v_exp_f32 v104, v104
    v_exp_f32 v105, v105
    v_pk_mul_f32 v[24:25], v[24:25], v[68:69]
    v_exp_f32 v106, v106
    v_exp_f32 v107, v107
    v_pk_mul_f32 v[26:27], v[26:27], v[68:69]
    v_exp_f32 v108, v108
    v_exp_f32 v109, v109
    v_pk_mul_f32 v[28:29], v[28:29], v[72:73]
    v_exp_f32 v110, v110
    v_exp_f32 v111, v111
    v_pk_mul_f32 v[30:31], v[30:31], v[72:73]
    v_pk_add_f32 v[96:97], v[96:97], v[132:133]
    v_pk_add_f32 v[98:99], v[98:99], v[132:133]
    v_pk_add_f32 v[100:101], v[100:101], v[132:133]
    v_pk_add_f32 v[102:103], v[102:103], v[132:133]
    v_pk_add_f32 v[104:105], v[104:105], v[132:133]
    v_pk_add_f32 v[106:107], v[106:107], v[132:133]
    v_pk_add_f32 v[108:109], v[108:109], v[132:133]
    v_pk_add_f32 v[110:111], v[110:111], v[132:133]
    v_rcp_f32 v96, v96
    v_rcp_f32 v97, v97
    v_rcp_f32 v98, v98
    v_rcp_f32 v99, v99
    v_rcp_f32 v100, v100
    v_rcp_f32 v101, v101
    v_rcp_f32 v102, v102
    v_rcp_f32 v103, v103
    v_rcp_f32 v104, v104
    v_rcp_f32 v105, v105
    v_rcp_f32 v106, v106
    v_rcp_f32 v107, v107
    v_rcp_f32 v108, v108
    v_rcp_f32 v109, v109
    v_rcp_f32 v110, v110
    v_rcp_f32 v111, v111
    s_nop 0
    v_pk_mul_f32 v[16:17], v[16:17], v[96:97]
    v_pk_mul_f32 v[18:19], v[18:19], v[98:99]
    v_pk_mul_f32 v[20:21], v[20:21], v[100:101]
    v_pk_mul_f32 v[22:23], v[22:23], v[102:103]
    v_pk_mul_f32 v[24:25], v[24:25], v[104:105]
    v_pk_mul_f32 v[26:27], v[26:27], v[106:107]
    v_pk_mul_f32 v[28:29], v[28:29], v[108:109]
    v_pk_mul_f32 v[30:31], v[30:31], v[110:111]
    v_cvt_pk_bf16_f32 v96, v16, v17
    v_cvt_pk_bf16_f32 v97, v18, v19
    v_cvt_pk_bf16_f32 v98, v24, v25
    v_cvt_pk_bf16_f32 v99, v26, v27
    buffer_store_dwordx4 v[96:99], v5, s[68:71], s74 offen offset:0 sc1
    v_cvt_pk_bf16_f32 v100, v20, v21
    v_cvt_pk_bf16_f32 v101, v22, v23
    v_cvt_pk_bf16_f32 v102, v28, v29
    v_cvt_pk_bf16_f32 v103, v30, v31
    buffer_store_dwordx4 v[100:103], v12, s[68:71], s74 offen offset:0 sc1
    v_pk_fma_f32 v[32:33], v[88:89], v[70:71], v[32:33] neg_lo:[0,1,0] neg_hi:[0,1,0]
    v_pk_fma_f32 v[34:35], v[90:91], v[70:71], v[34:35] neg_lo:[0,1,0] neg_hi:[0,1,0]
    v_pk_fma_f32 v[36:37], v[88:89], v[74:75], v[36:37] neg_lo:[0,1,0] neg_hi:[0,1,0]
    v_pk_fma_f32 v[38:39], v[90:91], v[74:75], v[38:39] neg_lo:[0,1,0] neg_hi:[0,1,0]
    v_pk_fma_f32 v[40:41], v[92:93], v[70:71], v[40:41] neg_lo:[0,1,0] neg_hi:[0,1,0]
    v_pk_fma_f32 v[42:43], v[94:95], v[70:71], v[42:43] neg_lo:[0,1,0] neg_hi:[0,1,0]
    v_pk_fma_f32 v[44:45], v[92:93], v[74:75], v[44:45] neg_lo:[0,1,0] neg_hi:[0,1,0]
    v_pk_fma_f32 v[46:47], v[94:95], v[74:75], v[46:47] neg_lo:[0,1,0] neg_hi:[0,1,0]
    v_pk_mul_f32 v[112:113], v[32:33], v[128:129]
    v_pk_mul_f32 v[114:115], v[34:35], v[128:129]
    v_pk_mul_f32 v[116:117], v[36:37], v[130:131]
    v_pk_mul_f32 v[118:119], v[38:39], v[130:131]
    v_pk_mul_f32 v[120:121], v[40:41], v[128:129]
    v_pk_mul_f32 v[122:123], v[42:43], v[128:129]
    v_pk_mul_f32 v[124:125], v[44:45], v[130:131]
    v_pk_mul_f32 v[126:127], v[46:47], v[130:131]
    v_exp_f32 v112, v112
    v_exp_f32 v113, v113
    v_pk_mul_f32 v[32:33], v[32:33], v[68:69]
    v_exp_f32 v114, v114
    v_exp_f32 v115, v115
    v_pk_mul_f32 v[34:35], v[34:35], v[68:69]
    v_exp_f32 v116, v116
    v_exp_f32 v117, v117
    v_pk_mul_f32 v[36:37], v[36:37], v[72:73]
    v_exp_f32 v118, v118
    v_exp_f32 v119, v119
    v_pk_mul_f32 v[38:39], v[38:39], v[72:73]
    v_exp_f32 v120, v120
    v_exp_f32 v121, v121
    v_pk_mul_f32 v[40:41], v[40:41], v[68:69]
    v_exp_f32 v122, v122
    v_exp_f32 v123, v123
    v_pk_mul_f32 v[42:43], v[42:43], v[68:69]
    v_exp_f32 v124, v124
    v_exp_f32 v125, v125
    v_pk_mul_f32 v[44:45], v[44:45], v[72:73]
    v_exp_f32 v126, v126
    v_exp_f32 v127, v127
    v_pk_mul_f32 v[46:47], v[46:47], v[72:73]
    v_pk_add_f32 v[112:113], v[112:113], v[132:133]
    v_pk_add_f32 v[114:115], v[114:115], v[132:133]
    v_pk_add_f32 v[116:117], v[116:117], v[132:133]
    v_pk_add_f32 v[118:119], v[118:119], v[132:133]
    v_pk_add_f32 v[120:121], v[120:121], v[132:133]
    v_pk_add_f32 v[122:123], v[122:123], v[132:133]
    v_pk_add_f32 v[124:125], v[124:125], v[132:133]
    v_pk_add_f32 v[126:127], v[126:127], v[132:133]
    v_rcp_f32 v112, v112
    v_rcp_f32 v113, v113
    v_rcp_f32 v114, v114
    v_rcp_f32 v115, v115
    v_rcp_f32 v116, v116
    v_rcp_f32 v117, v117
    v_rcp_f32 v118, v118
    v_rcp_f32 v119, v119
    v_rcp_f32 v120, v120
    v_rcp_f32 v121, v121
    v_rcp_f32 v122, v122
    v_rcp_f32 v123, v123
    v_rcp_f32 v124, v124
    v_rcp_f32 v125, v125
    v_rcp_f32 v126, v126
    v_rcp_f32 v127, v127
    s_nop 0
    v_pk_mul_f32 v[32:33], v[32:33], v[112:113]
    v_pk_mul_f32 v[34:35], v[34:35], v[114:115]
    v_pk_mul_f32 v[36:37], v[36:37], v[116:117]
    v_pk_mul_f32 v[38:39], v[38:39], v[118:119]
    v_pk_mul_f32 v[40:41], v[40:41], v[120:121]
    v_pk_mul_f32 v[42:43], v[42:43], v[122:123]
    v_pk_mul_f32 v[44:45], v[44:45], v[124:125]
    v_pk_mul_f32 v[46:47], v[46:47], v[126:127]
    v_cvt_pk_bf16_f32 v112, v32, v33
    v_cvt_pk_bf16_f32 v113, v34, v35
    v_cvt_pk_bf16_f32 v114, v40, v41
    v_cvt_pk_bf16_f32 v115, v42, v43
    buffer_store_dwordx4 v[112:115], v5, s[68:71], s74 offen offset:1024 sc1
    v_cvt_pk_bf16_f32 v116, v36, v37
    v_cvt_pk_bf16_f32 v117, v38, v39
    v_cvt_pk_bf16_f32 v118, v44, v45
    v_cvt_pk_bf16_f32 v119, v46, v47
    buffer_store_dwordx4 v[116:119], v12, s[68:71], s74 offen offset:1024 sc1
    s_branch L_g1_done
L_g1_b:
    ds_read_b64_tr_b16 v[80:81], v10 offset:0
    ds_read_b64_tr_b16 v[82:83], v10 offset:1792
    ds_read_b64_tr_b16 v[84:85], v10 offset:32
    ds_read_b64_tr_b16 v[86:87], v10 offset:1824
    ds_read_b64_tr_b16 v[88:89], v12 offset:0
    ds_read_b64_tr_b16 v[90:91], v12 offset:1792
    s_barrier
    ds_read_b64_tr_b16 v[64:65], v9 offset:0
    ds_read_b64_tr_b16 v[66:67], v9 offset:512
    ds_read_b64_tr_b16 v[68:69], v9 offset:256
    ds_read_b64_tr_b16 v[70:71], v9 offset:768
    s_waitcnt lgkmcnt(0)
    v_mfma_f32_16x16x32_bf16 v[16:19], v[80:83], v[64:67], v[16:19]
    ds_read_b64_tr_b16 v[72:73], v9 offset:2048
    ds_read_b64_tr_b16 v[74:75], v9 offset:2560
    v_mfma_f32_16x16x32_bf16 v[20:23], v[80:83], v[68:71], v[20:23]
    ds_read_b64_tr_b16 v[76:77], v9 offset:2304
    ds_read_b64_tr_b16 v[78:79], v9 offset:2816
    v_mfma_f32_16x16x32_bf16 v[24:27], v[84:87], v[64:67], v[24:27]
    ds_read_b64_tr_b16 v[96:97], v10 offset:7168
    ds_read_b64_tr_b16 v[98:99], v10 offset:8960
    v_mfma_f32_16x16x32_bf16 v[28:31], v[84:87], v[68:71], v[28:31]
    ds_read_b64_tr_b16 v[100:101], v10 offset:7200
    ds_read_b64_tr_b16 v[102:103], v10 offset:8992
    v_mfma_f32_16x16x32_bf16 v[32:35], v[88:91], v[64:67], v[32:35]
    ds_read_b64_tr_b16 v[104:105], v12 offset:7168
    ds_read_b64_tr_b16 v[106:107], v12 offset:8960
    v_mfma_f32_16x16x32_bf16 v[36:39], v[88:91], v[68:71], v[36:39]
    s_cmp_eq_u32 s28, 7
    s_cbranch_scc1 Lw1_46
    s_add_u32 m0, s95, 57344
    s_add_u32 s72, s88, 917504
    buffer_load_dwordx4 v133, s[52:55], s72 offen lds
Lw1_46:
    s_cmp_eq_u32 s28, 7
    s_cbranch_scc1 Lw1_47
    s_add_u32 m0, s95, 64512
    s_add_u32 s72, s88, 1032192
    buffer_load_dwordx4 v133, s[52:55], s72 offen lds
Lw1_47:
    v_mfma_f32_16x16x32_bf16 v[40:43], v[64:67], v[64:67], v[40:43]
    v_mfma_f32_16x16x32_bf16 v[48:51], v[56:59], v[64:67], v[48:51]
    v_mfma_f32_16x16x32_bf16 v[44:47], v[68:71], v[68:71], v[44:47]
    v_mfma_f32_16x16x32_bf16 v[52:55], v[56:59], v[68:71], v[52:55]
    s_waitcnt lgkmcnt(0)
    v_mfma_f32_16x16x32_bf16 v[16:19], v[96:99], v[72:75], v[16:19]
    s_barrier
    ds_read_b64_tr_b16 v[64:65], v9 offset:4096
    v_mfma_f32_16x16x32_bf16 v[20:23], v[96:99], v[76:79], v[20:23]
    ds_read_b64_tr_b16 v[66:67], v9 offset:4608
    ds_read_b64_tr_b16 v[68:69], v9 offset:4352
    v_mfma_f32_16x16x32_bf16 v[24:27], v[100:103], v[72:75], v[24:27]
    ds_read_b64_tr_b16 v[70:71], v9 offset:4864
    ds_read_b64_tr_b16 v[80:81], v10 offset:14336
    v_mfma_f32_16x16x32_bf16 v[28:31], v[100:103], v[76:79], v[28:31]
    ds_read_b64_tr_b16 v[82:83], v10 offset:16128
    ds_read_b64_tr_b16 v[84:85], v10 offset:14368
    v_mfma_f32_16x16x32_bf16 v[32:35], v[104:107], v[72:75], v[32:35]
    ds_read_b64_tr_b16 v[86:87], v10 offset:16160
    ds_read_b64_tr_b16 v[88:89], v12 offset:14336
    v_mfma_f32_16x16x32_bf16 v[36:39], v[104:107], v[76:79], v[36:39]
    ds_read_b64_tr_b16 v[90:91], v12 offset:16128
    s_cmp_eq_u32 s28, 7
    s_cbranch_scc1 Lw1_48
    s_add_u32 m0, s95, 71680
    s_add_u32 s72, s88, 1146880
    buffer_load_dwordx4 v133, s[52:55], s72 offen lds
Lw1_48:
    v_mfma_f32_16x16x32_bf16 v[40:43], v[72:75], v[72:75], v[40:43]
    s_cmp_eq_u32 s28, 7
    s_cbranch_scc1 Lw1_49
    s_add_u32 m0, s95, 78848
    s_add_u32 s72, s88, 1261568
    buffer_load_dwordx4 v133, s[52:55], s72 offen lds
Lw1_49:
    s_cmp_eq_u32 s79, 0
    s_cselect_b32 s72, s89, 2146435072
    buffer_load_dword v134, v14, s[68:71], s72 offen
    v_mfma_f32_16x16x32_bf16 v[48:51], v[56:59], v[72:75], v[48:51]
    v_mfma_f32_16x16x32_bf16 v[44:47], v[76:79], v[76:79], v[44:47]
    v_mfma_f32_16x16x32_bf16 v[52:55], v[56:59], v[76:79], v[52:55]
    s_waitcnt lgkmcnt(0)
    v_mfma_f32_16x16x32_bf16 v[16:19], v[80:83], v[64:67], v[16:19]
    ds_read_b64_tr_b16 v[72:73], v9 offset:6144
    ds_read_b64_tr_b16 v[74:75], v9 offset:6656
    v_mfma_f32_16x16x32_bf16 v[20:23], v[80:83], v[68:71], v[20:23]
    ds_read_b64_tr_b16 v[76:77], v9 offset:6400
    ds_read_b64_tr_b16 v[78:79], v9 offset:6912
    v_mfma_f32_16x16x32_bf16 v[24:27], v[84:87], v[64:67], v[24:27]
    ds_read_b64_tr_b16 v[96:97], v10 offset:21504
    ds_read_b64_tr_b16 v[98:99], v10 offset:23296
    v_mfma_f32_16x16x32_bf16 v[28:31], v[84:87], v[68:71], v[28:31]
    ds_read_b64_tr_b16 v[100:101], v10 offset:21536
    ds_read_b64_tr_b16 v[102:103], v10 offset:23328
    v_mfma_f32_16x16x32_bf16 v[32:35], v[88:91], v[64:67], v[32:35]
    ds_read_b64_tr_b16 v[104:105], v12 offset:21504
    ds_read_b64_tr_b16 v[106:107], v12 offset:23296
    v_mfma_f32_16x16x32_bf16 v[36:39], v[88:91], v[68:71], v[36:39]
    s_cmp_eq_u32 s28, 7
    s_cbranch_scc1 Lw1_51
    s_add_u32 m0, s95, 86016
    s_add_u32 s72, s88, 1376256
    buffer_load_dwordx4 v133, s[52:55], s72 offen lds
Lw1_51:
    s_cmp_eq_u32 s28, 7
    s_cbranch_scc1 Lw1_52
    s_add_u32 m0, s95, 93184
    s_add_u32 s72, s88, 1490944
    buffer_load_dwordx4 v133, s[52:55], s72 offen lds
Lw1_52:
    v_mfma_f32_16x16x32_bf16 v[40:43], v[64:67], v[64:67], v[40:43]
    v_mfma_f32_16x16x32_bf16 v[48:51], v[56:59], v[64:67], v[48:51]
    v_mfma_f32_16x16x32_bf16 v[44:47], v[68:71], v[68:71], v[44:47]
    v_mfma_f32_16x16x32_bf16 v[52:55], v[56:59], v[68:71], v[52:55]
    s_waitcnt lgkmcnt(0)
    v_mfma_f32_16x16x32_bf16 v[16:19], v[96:99], v[72:75], v[16:19]
    s_barrier
    ds_read_b64_tr_b16 v[64:65], v9 offset:8192
    v_mfma_f32_16x16x32_bf16 v[20:23], v[96:99], v[76:79], v[20:23]
    ds_read_b64_tr_b16 v[66:67], v9 offset:8704
    ds_read_b64_tr_b16 v[68:69], v9 offset:8448
    v_mfma_f32_16x16x32_bf16 v[24:27], v[100:103], v[72:75], v[24:27]
    ds_read_b64_tr_b16 v[70:71], v9 offset:8960
    ds_read_b64_tr_b16 v[80:81], v10 offset:28672
    v_mfma_f32_16x16x32_bf16 v[28:31], v[100:103], v[76:79], v[28:31]
    ds_read_b64_tr_b16 v[82:83], v10 offset:30464
    ds_read_b64_tr_b16 v[84:85], v10 offset:28704
    v_mfma_f32_16x16x32_bf16 v[32:35], v[104:107], v[72:75], v[32:35]
    ds_read_b64_tr_b16 v[86:87], v10 offset:30496
    ds_read_b64_tr_b16 v[88:89], v12 offset:28672
    v_mfma_f32_16x16x32_bf16 v[36:39], v[104:107], v[76:79], v[36:39]
    ds_read_b64_tr_b16 v[90:91], v12 offset:30464
    s_cmp_eq_u32 s28, 7
    s_cbranch_scc1 Lw1_53
    s_add_u32 m0, s95, 100352
    s_add_u32 s72, s88, 1605632
    buffer_load_dwordx4 v133, s[52:55], s72 offen lds
Lw1_53:
    v_mfma_f32_16x16x32_bf16 v[40:43], v[72:75], v[72:75], v[40:43]
    s_cmp_eq_u32 s28, 7
    s_cbranch_scc1 Lw1_54
    s_add_u32 m0, s95, 107520
    s_add_u32 s72, s88, 1720320
    buffer_load_dwordx4 v133, s[52:55], s72 offen lds
Lw1_54:
    s_cmp_eq_u32 s79, 1
    s_cselect_b32 s72, s89, 2146435072
    buffer_load_dword v134, v14, s[68:71], s72 offen
    v_mfma_f32_16x16x32_bf16 v[48:51], v[56:59], v[72:75], v[48:51]
    v_mfma_f32_16x16x32_bf16 v[44:47], v[76:79], v[76:79], v[44:47]
    v_mfma_f32_16x16x32_bf16 v[52:55], v[56:59], v[76:79], v[52:55]
    s_waitcnt lgkmcnt(0)
    v_mfma_f32_16x16x32_bf16 v[16:19], v[80:83], v[64:67], v[16:19]
    ds_read_b64_tr_b16 v[72:73], v9 offset:10240
    v_mfma_f32_16x16x32_bf16 v[20:23], v[80:83], v[68:71], v[20:23]
    ds_read_b64_tr_b16 v[74:75], v9 offset:10752
    v_mfma_f32_16x16x32_bf16 v[24:27], v[84:87], v[64:67], v[24:27]
    ds_read_b64_tr_b16 v[76:77], v9 offset:10496
    v_mfma_f32_16x16x32_bf16 v[28:31], v[84:87], v[68:71], v[28:31]
    ds_read_b64_tr_b16 v[78:79], v9 offset:11008
    v_mfma_f32_16x16x32_bf16 v[32:35], v[88:91], v[64:67], v[32:35]
    ds_read_b64_tr_b16 v[96:97], v10 offset:35840
    v_mfma_f32_16x16x32_bf16 v[36:39], v[88:91], v[68:71], v[36:39]
    ds_read_b64_tr_b16 v[98:99], v10 offset:37632
    v_mfma_f32_16x16x32_bf16 v[40:43], v[64:67], v[64:67], v[40:43]
    ds_read_b64_tr_b16 v[100:101], v10 offset:35872
    v_mfma_f32_16x16x32_bf16 v[48:51], v[56:59], v[64:67], v[48:51]
    ds_read_b64_tr_b16 v[102:103], v10 offset:37664
    v_mfma_f32_16x16x32_bf16 v[44:47], v[68:71], v[68:71], v[44:47]
    ds_read_b64_tr_b16 v[104:105], v12 offset:35840
    v_mfma_f32_16x16x32_bf16 v[52:55], v[56:59], v[68:71], v[52:55]
    ds_read_b64_tr_b16 v[106:107], v12 offset:37632
    s_waitcnt lgkmcnt(0)
    v_mfma_f32_16x16x32_bf16 v[16:19], v[96:99], v[72:75], v[16:19]
    s_barrier
    ds_read_b64_tr_b16 v[64:65], v9 offset:0
    v_mfma_f32_16x16x32_bf16 v[20:23], v[96:99], v[76:79], v[20:23]
    ds_read_b64_tr_b16 v[66:67], v9 offset:512
    ds_read_b64_tr_b16 v[68:69], v9 offset:256
    v_mfma_f32_16x16x32_bf16 v[24:27], v[100:103], v[72:75], v[24:27]
    ds_read_b64_tr_b16 v[70:71], v9 offset:768
    ds_read_b64_tr_b16 v[80:81], v10 offset:43008
    v_mfma_f32_16x16x32_bf16 v[28:31], v[100:103], v[76:79], v[28:31]
    ds_read_b64_tr_b16 v[82:83], v10 offset:44800
    ds_read_b64_tr_b16 v[84:85], v10 offset:43040
    v_mfma_f32_16x16x32_bf16 v[32:35], v[104:107], v[72:75], v[32:35]
    ds_read_b64_tr_b16 v[86:87], v10 offset:44832
    ds_read_b64_tr_b16 v[88:89], v12 offset:43008
    v_mfma_f32_16x16x32_bf16 v[36:39], v[104:107], v[76:79], v[36:39]
    ds_read_b64_tr_b16 v[90:91], v12 offset:44800
    s_cmp_eq_u32 s79, 2
    s_cselect_b32 s72, s89, 2146435072
    buffer_load_dword v134, v14, s[68:71], s72 offen
    v_mfma_f32_16x16x32_bf16 v[40:43], v[72:75], v[72:75], v[40:43]
    v_mfma_f32_16x16x32_bf16 v[48:51], v[56:59], v[72:75], v[48:51]
    v_mfma_f32_16x16x32_bf16 v[44:47], v[76:79], v[76:79], v[44:47]
    v_mfma_f32_16x16x32_bf16 v[52:55], v[56:59], v[76:79], v[52:55]
    s_waitcnt lgkmcnt(0)
    v_mfma_f32_16x16x32_bf16 v[16:19], v[80:83], v[64:67], v[16:19]
    ds_read_b64_tr_b16 v[72:73], v9 offset:2048
    v_mfma_f32_16x16x32_bf16 v[20:23], v[80:83], v[68:71], v[20:23]
    ds_read_b64_tr_b16 v[74:75], v9 offset:2560
    v_mfma_f32_16x16x32_bf16 v[24:27], v[84:87], v[64:67], v[24:27]
    ds_read_b64_tr_b16 v[76:77], v9 offset:2304
    v_mfma_f32_16x16x32_bf16 v[28:31], v[84:87], v[68:71], v[28:31]
    ds_read_b64_tr_b16 v[78:79], v9 offset:2816
    v_mfma_f32_16x16x32_bf16 v[32:35], v[88:91], v[64:67], v[32:35]
    ds_read_b64_tr_b16 v[96:97], v10 offset:50176
    v_mfma_f32_16x16x32_bf16 v[36:39], v[88:91], v[68:71], v[36:39]
    ds_read_b64_tr_b16 v[98:99], v10 offset:51968
    v_mfma_f32_16x16x32_bf16 v[40:43], v[64:67], v[64:67], v[40:43]
    ds_read_b64_tr_b16 v[100:101], v10 offset:50208
    v_mfma_f32_16x16x32_bf16 v[48:51], v[56:59], v[64:67], v[48:51]
    ds_read_b64_tr_b16 v[102:103], v10 offset:52000
    v_mfma_f32_16x16x32_bf16 v[44:47], v[68:71], v[68:71], v[44:47]
    ds_read_b64_tr_b16 v[104:105], v12 offset:50176
    v_mfma_f32_16x16x32_bf16 v[52:55], v[56:59], v[68:71], v[52:55]
    ds_read_b64_tr_b16 v[106:107], v12 offset:51968
    s_waitcnt lgkmcnt(0)
    v_mfma_f32_16x16x32_bf16 v[16:19], v[96:99], v[72:75], v[16:19]
    s_waitcnt vmcnt(9)
    s_barrier
    v_mfma_f32_16x16x32_bf16 v[20:23], v[96:99], v[76:79], v[20:23]
    ds_read_b64_tr_b16 v[64:65], v9 offset:4096
    ds_read_b64_tr_b16 v[66:67], v9 offset:4608
    v_mfma_f32_16x16x32_bf16 v[24:27], v[100:103], v[72:75], v[24:27]
    ds_read_b64_tr_b16 v[68:69], v9 offset:4352
    ds_read_b64_tr_b16 v[70:71], v9 offset:4864
    v_mfma_f32_16x16x32_bf16 v[28:31], v[100:103], v[76:79], v[28:31]
    ds_read_b64_tr_b16 v[80:81], v11 offset:0
    ds_read_b64_tr_b16 v[82:83], v11 offset:1792
    v_mfma_f32_16x16x32_bf16 v[32:35], v[104:107], v[72:75], v[32:35]
    ds_read_b64_tr_b16 v[84:85], v11 offset:32
    ds_read_b64_tr_b16 v[86:87], v11 offset:1824
    v_mfma_f32_16x16x32_bf16 v[36:39], v[104:107], v[76:79], v[36:39]
    ds_read_b64_tr_b16 v[88:89], v13 offset:0
    ds_read_b64_tr_b16 v[90:91], v13 offset:1792
    v_mfma_f32_16x16x32_bf16 v[40:43], v[72:75], v[72:75], v[40:43]
    ds_read_b64_tr_b16 v[112:113], v189 offset:0
    ds_read_b64_tr_b16 v[114:115], v189 offset:1792
    v_mfma_f32_16x16x32_bf16 v[48:51], v[56:59], v[72:75], v[48:51]
    s_cmp_eq_u32 s79, 3
    s_cselect_b32 s72, s89, 2146435072
    buffer_load_dword v134, v14, s[68:71], s72 offen
    v_mfma_f32_16x16x32_bf16 v[44:47], v[76:79], v[76:79], v[44:47]
    v_mfma_f32_16x16x32_bf16 v[52:55], v[56:59], v[76:79], v[52:55]
    s_waitcnt lgkmcnt(0)
    v_mfma_f32_16x16x32_bf16 v[16:19], v[80:83], v[64:67], v[16:19]
    ds_read_b64_tr_b16 v[72:73], v9 offset:6144
    ds_read_b64_tr_b16 v[74:75], v9 offset:6656
    v_mfma_f32_16x16x32_bf16 v[20:23], v[80:83], v[68:71], v[20:23]
    ds_read_b64_tr_b16 v[76:77], v9 offset:6400
    ds_read_b64_tr_b16 v[78:79], v9 offset:6912
    v_mfma_f32_16x16x32_bf16 v[24:27], v[84:87], v[64:67], v[24:27]
    ds_read_b64_tr_b16 v[96:97], v11 offset:7168
    ds_read_b64_tr_b16 v[98:99], v11 offset:8960
    v_mfma_f32_16x16x32_bf16 v[28:31], v[84:87], v[68:71], v[28:31]
    ds_read_b64_tr_b16 v[100:101], v11 offset:7200
    ds_read_b64_tr_b16 v[102:103], v11 offset:8992
    v_mfma_f32_16x16x32_bf16 v[32:35], v[88:91], v[64:67], v[32:35]
    ds_read_b64_tr_b16 v[104:105], v13 offset:7168
    ds_read_b64_tr_b16 v[106:107], v13 offset:8960
    v_mfma_f32_16x16x32_bf16 v[36:39], v[88:91], v[68:71], v[36:39]
    ds_read_b64_tr_b16 v[116:117], v189 offset:7168
    ds_read_b64_tr_b16 v[118:119], v189 offset:8960
    v_mfma_f32_16x16x32_bf16 v[40:43], v[64:67], v[64:67], v[40:43]
    v_mfma_f32_16x16x32_bf16 v[48:51], v[56:59], v[64:67], v[48:51]
    v_mfma_f32_16x16x32_bf16 v[44:47], v[68:71], v[68:71], v[44:47]
    v_mfma_f32_16x16x32_bf16 v[52:55], v[56:59], v[68:71], v[52:55]
    v_mfma_f32_16x16x32_bf16 v[60:63], v[112:115], v[56:59], v[60:63]
    s_waitcnt lgkmcnt(0)
    v_mfma_f32_16x16x32_bf16 v[16:19], v[96:99], v[72:75], v[16:19]
    s_waitcnt vmcnt(8)
    s_barrier
    v_mfma_f32_16x16x32_bf16 v[20:23], v[96:99], v[76:79], v[20:23]
    ds_read_b64_tr_b16 v[64:65], v9 offset:8192
    ds_read_b64_tr_b16 v[66:67], v9 offset:8704
    v_mfma_f32_16x16x32_bf16 v[24:27], v[100:103], v[72:75], v[24:27]
    ds_read_b64_tr_b16 v[68:69], v9 offset:8448
    ds_read_b64_tr_b16 v[70:71], v9 offset:8960
    v_mfma_f32_16x16x32_bf16 v[28:31], v[100:103], v[76:79], v[28:31]
    ds_read_b64_tr_b16 v[80:81], v11 offset:14336
    ds_read_b64_tr_b16 v[82:83], v11 offset:16128
    v_mfma_f32_16x16x32_bf16 v[32:35], v[104:107], v[72:75], v[32:35]
    ds_read_b64_tr_b16 v[84:85], v11 offset:14368
    ds_read_b64_tr_b16 v[86:87], v11 offset:16160
    v_mfma_f32_16x16x32_bf16 v[36:39], v[104:107], v[76:79], v[36:39]
    ds_read_b64_tr_b16 v[88:89], v13 offset:14336
    ds_read_b64_tr_b16 v[90:91], v13 offset:16128
    v_mfma_f32_16x16x32_bf16 v[40:43], v[72:75], v[72:75], v[40:43]
    ds_read_b64_tr_b16 v[112:113], v189 offset:14336
    ds_read_b64_tr_b16 v[114:115], v189 offset:16128
    v_mfma_f32_16x16x32_bf16 v[48:51], v[56:59], v[72:75], v[48:51]
    v_mfma_f32_16x16x32_bf16 v[44:47], v[76:79], v[76:79], v[44:47]
    v_mfma_f32_16x16x32_bf16 v[52:55], v[56:59], v[76:79], v[52:55]
    v_mfma_f32_16x16x32_bf16 v[60:63], v[116:119], v[56:59], v[60:63]
    s_waitcnt lgkmcnt(0)
    v_mfma_f32_16x16x32_bf16 v[16:19], v[80:83], v[64:67], v[16:19]
    ds_read_b64_tr_b16 v[72:73], v9 offset:10240
    ds_read_b64_tr_b16 v[74:75], v9 offset:10752
    v_mfma_f32_16x16x32_bf16 v[20:23], v[80:83], v[68:71], v[20:23]
    ds_read_b64_tr_b16 v[76:77], v9 offset:10496
    ds_read_b64_tr_b16 v[78:79], v9 offset:11008
    v_mfma_f32_16x16x32_bf16 v[24:27], v[84:87], v[64:67], v[24:27]
    ds_read_b64_tr_b16 v[96:97], v11 offset:21504
    ds_read_b64_tr_b16 v[98:99], v11 offset:23296
    v_mfma_f32_16x16x32_bf16 v[28:31], v[84:87], v[68:71], v[28:31]
    ds_read_b64_tr_b16 v[100:101], v11 offset:21536
    ds_read_b64_tr_b16 v[102:103], v11 offset:23328
    v_mfma_f32_16x16x32_bf16 v[32:35], v[88:91], v[64:67], v[32:35]
    ds_read_b64_tr_b16 v[104:105], v13 offset:21504
    ds_read_b64_tr_b16 v[106:107], v13 offset:23296
    v_mfma_f32_16x16x32_bf16 v[36:39], v[88:91], v[68:71], v[36:39]
    ds_read_b64_tr_b16 v[116:117], v189 offset:21504
    ds_read_b64_tr_b16 v[118:119], v189 offset:23296
    v_mfma_f32_16x16x32_bf16 v[40:43], v[64:67], v[64:67], v[40:43]
    s_add_u32 s74, s31, 0
    buffer_load_dwordx4 v[192:195], v5, s[68:71], s74 offen offset:0 sc1
    s_add_u32 s74, s31, 0
    buffer_load_dwordx4 v[196:199], v5, s[68:71], s74 offen offset:1024 sc1
    v_mfma_f32_16x16x32_bf16 v[48:51], v[56:59], v[64:67], v[48:51]
    s_add_u32 s74, s31, 0
    buffer_load_dwordx4 v[200:203], v5, s[68:71], s74 offen offset:2048 sc1
    v_mfma_f32_16x16x32_bf16 v[44:47], v[68:71], v[68:71], v[44:47]
    v_mfma_f32_16x16x32_bf16 v[52:55], v[56:59], v[68:71], v[52:55]
    v_mfma_f32_16x16x32_bf16 v[60:63], v[112:115], v[56:59], v[60:63]
    s_waitcnt lgkmcnt(0)
    v_mfma_f32_16x16x32_bf16 v[16:19], v[96:99], v[72:75], v[16:19]
    s_waitcnt vmcnt(8)
    s_barrier
    v_mfma_f32_16x16x32_bf16 v[20:23], v[96:99], v[76:79], v[20:23]
    ds_read_b64_tr_b16 v[64:65], v9 offset:0
    ds_read_b64_tr_b16 v[66:67], v9 offset:512
    v_mfma_f32_16x16x32_bf16 v[24:27], v[100:103], v[72:75], v[24:27]
    ds_read_b64_tr_b16 v[68:69], v9 offset:256
    ds_read_b64_tr_b16 v[70:71], v9 offset:768
    v_mfma_f32_16x16x32_bf16 v[28:31], v[100:103], v[76:79], v[28:31]
    ds_read_b64_tr_b16 v[80:81], v11 offset:28672
    ds_read_b64_tr_b16 v[82:83], v11 offset:30464
    v_mfma_f32_16x16x32_bf16 v[32:35], v[104:107], v[72:75], v[32:35]
    ds_read_b64_tr_b16 v[84:85], v11 offset:28704
    ds_read_b64_tr_b16 v[86:87], v11 offset:30496
    v_mfma_f32_16x16x32_bf16 v[36:39], v[104:107], v[76:79], v[36:39]
    ds_read_b64_tr_b16 v[88:89], v13 offset:28672
    ds_read_b64_tr_b16 v[90:91], v13 offset:30464
    v_mfma_f32_16x16x32_bf16 v[40:43], v[72:75], v[72:75], v[40:43]
    ds_read_b64_tr_b16 v[112:113], v189 offset:28672
    ds_read_b64_tr_b16 v[114:115], v189 offset:30464
    v_mfma_f32_16x16x32_bf16 v[48:51], v[56:59], v[72:75], v[48:51]
    s_add_u32 s74, s31, 0
    buffer_load_dwordx4 v[204:207], v5, s[68:71], s74 offen offset:3072 sc1
    s_add_u32 s74, s31, 4096
    buffer_load_dwordx4 v[208:211], v5, s[68:71], s74 offen offset:0 sc1
    v_mfma_f32_16x16x32_bf16 v[44:47], v[76:79], v[76:79], v[44:47]
    s_add_u32 s74, s31, 4096
    buffer_load_dwordx4 v[212:215], v5, s[68:71], s74 offen offset:1024 sc1
    v_mfma_f32_16x16x32_bf16 v[52:55], v[56:59], v[76:79], v[52:55]
    v_mfma_f32_16x16x32_bf16 v[60:63], v[116:119], v[56:59], v[60:63]
    s_waitcnt lgkmcnt(0)
    v_mfma_f32_16x16x32_bf16 v[16:19], v[80:83], v[64:67], v[16:19]
    ds_read_b64_tr_b16 v[72:73], v9 offset:2048
    ds_read_b64_tr_b16 v[74:75], v9 offset:2560
    v_mfma_f32_16x16x32_bf16 v[20:23], v[80:83], v[68:71], v[20:23]
    ds_read_b64_tr_b16 v[76:77], v9 offset:2304
    ds_read_b64_tr_b16 v[78:79], v9 offset:2816
    v_mfma_f32_16x16x32_bf16 v[24:27], v[84:87], v[64:67], v[24:27]
    ds_read_b64_tr_b16 v[96:97], v11 offset:35840
    ds_read_b64_tr_b16 v[98:99], v11 offset:37632
    v_mfma_f32_16x16x32_bf16 v[28:31], v[84:87], v[68:71], v[28:31]
    ds_read_b64_tr_b16 v[100:101], v11 offset:35872
    ds_read_b64_tr_b16 v[102:103], v11 offset:37664
    v_mfma_f32_16x16x32_bf16 v[32:35], v[88:91], v[64:67], v[32:35]
    ds_read_b64_tr_b16 v[104:105], v13 offset:35840
    ds_read_b64_tr_b16 v[106:107], v13 offset:37632
    v_mfma_f32_16x16x32_bf16 v[36:39], v[88:91], v[68:71], v[36:39]
    ds_read_b64_tr_b16 v[116:117], v189 offset:35840
    ds_read_b64_tr_b16 v[118:119], v189 offset:37632
    v_mfma_f32_16x16x32_bf16 v[40:43], v[64:67], v[64:67], v[40:43]
    s_add_u32 s74, s31, 4096
    buffer_load_dwordx4 v[216:219], v5, s[68:71], s74 offen offset:2048 sc1
    s_add_u32 s74, s31, 4096
    buffer_load_dwordx4 v[220:223], v5, s[68:71], s74 offen offset:3072 sc1
    v_mfma_f32_16x16x32_bf16 v[48:51], v[56:59], v[64:67], v[48:51]
    s_add_u32 s74, s31, 8192
    buffer_load_dwordx4 v[224:227], v5, s[68:71], s74 offen offset:0 sc1
    v_mfma_f32_16x16x32_bf16 v[44:47], v[68:71], v[68:71], v[44:47]
    v_mfma_f32_16x16x32_bf16 v[52:55], v[56:59], v[68:71], v[52:55]
    v_mfma_f32_16x16x32_bf16 v[60:63], v[112:115], v[56:59], v[60:63]
    s_waitcnt lgkmcnt(0)
    v_mfma_f32_16x16x32_bf16 v[16:19], v[96:99], v[72:75], v[16:19]
    s_waitcnt vmcnt(12)
    s_barrier
    v_mfma_f32_16x16x32_bf16 v[20:23], v[96:99], v[76:79], v[20:23]
    ds_read_b64_tr_b16 v[64:65], v9 offset:4096
    ds_read_b64_tr_b16 v[66:67], v9 offset:4608
    v_mfma_f32_16x16x32_bf16 v[24:27], v[100:103], v[72:75], v[24:27]
    ds_read_b64_tr_b16 v[68:69], v9 offset:4352
    ds_read_b64_tr_b16 v[70:71], v9 offset:4864
    v_mfma_f32_16x16x32_bf16 v[28:31], v[100:103], v[76:79], v[28:31]
    ds_read_b64_tr_b16 v[80:81], v11 offset:43008
    ds_read_b64_tr_b16 v[82:83], v11 offset:44800
    v_mfma_f32_16x16x32_bf16 v[32:35], v[104:107], v[72:75], v[32:35]
    ds_read_b64_tr_b16 v[84:85], v11 offset:43040
    ds_read_b64_tr_b16 v[86:87], v11 offset:44832
    v_mfma_f32_16x16x32_bf16 v[36:39], v[104:107], v[76:79], v[36:39]
    ds_read_b64_tr_b16 v[88:89], v13 offset:43008
    ds_read_b64_tr_b16 v[90:91], v13 offset:44800
    v_mfma_f32_16x16x32_bf16 v[40:43], v[72:75], v[72:75], v[40:43]
    ds_read_b64_tr_b16 v[112:113], v189 offset:43008
    ds_read_b64_tr_b16 v[114:115], v189 offset:44800
    v_mfma_f32_16x16x32_bf16 v[48:51], v[56:59], v[72:75], v[48:51]
    s_add_u32 s74, s31, 8192
    buffer_load_dwordx4 v[228:231], v5, s[68:71], s74 offen offset:1024 sc1
    s_add_u32 s74, s31, 8192
    buffer_load_dwordx4 v[232:235], v5, s[68:71], s74 offen offset:2048 sc1
    v_mfma_f32_16x16x32_bf16 v[44:47], v[76:79], v[76:79], v[44:47]
    s_add_u32 s74, s31, 8192
    buffer_load_dwordx4 v[236:239], v5, s[68:71], s74 offen offset:3072 sc1
    v_mfma_f32_16x16x32_bf16 v[52:55], v[56:59], v[76:79], v[52:55]
    v_mfma_f32_16x16x32_bf16 v[60:63], v[116:119], v[56:59], v[60:63]
    s_waitcnt lgkmcnt(0)
    v_mfma_f32_16x16x32_bf16 v[16:19], v[80:83], v[64:67], v[16:19]
    ds_read_b64_tr_b16 v[72:73], v9 offset:6144
    ds_read_b64_tr_b16 v[74:75], v9 offset:6656
    v_mfma_f32_16x16x32_bf16 v[20:23], v[80:83], v[68:71], v[20:23]
    ds_read_b64_tr_b16 v[76:77], v9 offset:6400
    ds_read_b64_tr_b16 v[78:79], v9 offset:6912
    v_mfma_f32_16x16x32_bf16 v[24:27], v[84:87], v[64:67], v[24:27]
    ds_read_b64_tr_b16 v[96:97], v11 offset:50176
    ds_read_b64_tr_b16 v[98:99], v11 offset:51968
    v_mfma_f32_16x16x32_bf16 v[28:31], v[84:87], v[68:71], v[28:31]
    ds_read_b64_tr_b16 v[100:101], v11 offset:50208
    ds_read_b64_tr_b16 v[102:103], v11 offset:52000
    v_mfma_f32_16x16x32_bf16 v[32:35], v[88:91], v[64:67], v[32:35]
    ds_read_b64_tr_b16 v[104:105], v13 offset:50176
    ds_read_b64_tr_b16 v[106:107], v13 offset:51968
    v_mfma_f32_16x16x32_bf16 v[36:39], v[88:91], v[68:71], v[36:39]
    ds_read_b64_tr_b16 v[116:117], v189 offset:50176
    ds_read_b64_tr_b16 v[118:119], v189 offset:51968
    v_mfma_f32_16x16x32_bf16 v[40:43], v[64:67], v[64:67], v[40:43]
    s_add_u32 s74, s31, 12288
    buffer_load_dwordx4 v[240:243], v5, s[68:71], s74 offen offset:0 sc1
    s_add_u32 s74, s31, 12288
    buffer_load_dwordx4 v[244:247], v5, s[68:71], s74 offen offset:1024 sc1
    v_mfma_f32_16x16x32_bf16 v[48:51], v[56:59], v[64:67], v[48:51]
    s_add_u32 s74, s31, 12288
    buffer_load_dwordx4 v[248:251], v5, s[68:71], s74 offen offset:2048 sc1
    v_mfma_f32_16x16x32_bf16 v[44:47], v[68:71], v[68:71], v[44:47]
    v_mfma_f32_16x16x32_bf16 v[52:55], v[56:59], v[68:71], v[52:55]
    v_mfma_f32_16x16x32_bf16 v[60:63], v[112:115], v[56:59], v[60:63]
    s_waitcnt lgkmcnt(0)
    v_mfma_f32_16x16x32_bf16 v[16:19], v[96:99], v[72:75], v[16:19]
    s_add_u32 s74, s31, 12288
    buffer_load_dwordx4 v[252:255], v5, s[68:71], s74 offen offset:3072 sc1
    v_mfma_f32_16x16x32_bf16 v[20:23], v[96:99], v[76:79], v[20:23]
    s_add_u32 s74, s31, 16384
    buffer_load_dwordx4 v[136:139], v5, s[68:71], s74 offen offset:0 sc1
    v_mfma_f32_16x16x32_bf16 v[24:27], v[100:103], v[72:75], v[24:27]
    s_add_u32 s74, s31, 16384
    buffer_load_dwordx4 v[140:143], v5, s[68:71], s74 offen offset:1024 sc1
    v_mfma_f32_16x16x32_bf16 v[28:31], v[100:103], v[76:79], v[28:31]
    v_mfma_f32_16x16x32_bf16 v[32:35], v[104:107], v[72:75], v[32:35]
    v_mfma_f32_16x16x32_bf16 v[36:39], v[104:107], v[76:79], v[36:39]
    v_mfma_f32_16x16x32_bf16 v[40:43], v[72:75], v[72:75], v[40:43]
    v_mfma_f32_16x16x32_bf16 v[48:51], v[56:59], v[72:75], v[48:51]
    v_mfma_f32_16x16x32_bf16 v[44:47], v[76:79], v[76:79], v[44:47]
    v_mfma_f32_16x16x32_bf16 v[52:55], v[56:59], v[76:79], v[52:55]
    v_mfma_f32_16x16x32_bf16 v[60:63], v[116:119], v[56:59], v[60:63]
    s_add_u32 s74, s31, 16384
    buffer_load_dwordx4 v[144:147], v5, s[68:71], s74 offen offset:2048 sc1
    s_add_u32 s74, s31, 16384
    buffer_load_dwordx4 v[148:151], v5, s[68:71], s74 offen offset:3072 sc1
    s_add_u32 s74, s31, 20480
    buffer_load_dwordx4 v[152:155], v5, s[68:71], s74 offen offset:0 sc1
    s_add_u32 s74, s31, 20480
    buffer_load_dwordx4 v[156:159], v5, s[68:71], s74 offen offset:1024 sc1
    s_add_u32 s74, s31, 20480
    buffer_load_dwordx4 v[160:163], v5, s[68:71], s74 offen offset:2048 sc1
    s_add_u32 s74, s31, 20480
    buffer_load_dwordx4 v[164:167], v5, s[68:71], s74 offen offset:3072 sc1
    s_add_u32 s74, s31, 24576
    buffer_load_dwordx4 v[168:171], v5, s[68:71], s74 offen offset:0 sc1
    s_add_u32 s74, s31, 24576
    buffer_load_dwordx4 v[172:175], v5, s[68:71], s74 offen offset:1024 sc1
    s_add_u32 s74, s31, 24576
    buffer_load_dwordx4 v[176:179], v5, s[68:71], s74 offen offset:2048 sc1
    s_add_u32 s74, s31, 24576
    buffer_load_dwordx4 v[180:183], v5, s[68:71], s74 offen offset:3072 sc1
    s_barrier
    v_lshlrev_b32 v10, 4, v3
    s_lshl_b32 s72, s28, 6
    v_add_u32 v4, s72, v10
    s_mov_b32 exec_lo, 0x00010001
    s_mov_b32 exec_hi, 0x00010001
    ds_write_b128 v4, v[60:63] offset:0
    s_mov_b64 exec, -1
    s_lshl_b32 s72, s79, 8
    v_lshlrev_b32 v11, 3, v2
    v_add_u32 v11, s72, v11
    v_and_b32 v4, 3, v2
    v_cmp_eq_u32 s[72:73], 1, v4
    v_cmp_eq_u32 s[74:75], 2, v4
    v_cmp_eq_u32 s[76:77], 3, v4
    v_lshrrev_b32 v4, 2, v2
    v_cmp_eq_u32 vcc, v4, v3
    v_cndmask_b32_e64 v40, v40, v41, s[72:73]
    v_cndmask_b32_e64 v40, v40, v42, s[74:75]
    v_cndmask_b32_e64 v41, v40, v43, s[76:77]
    v_mov_b32 v40, v48
    v_cndmask_b32_e64 v44, v44, v45, s[72:73]
    v_cndmask_b32_e64 v44, v44, v46, s[74:75]
    v_cndmask_b32_e64 v45, v44, v47, s[76:77]
    v_mov_b32 v44, v52
    s_mov_b64 exec, vcc
    ds_write_b64 v11, v[40:41] offset:1024
    ds_write_b64 v11, v[44:45] offset:1152
    s_mov_b64 exec, -1
    s_mul_i32 s72, s90, 57344
    s_add_u32 s72, s72, 12582912
    s_mul_i32 s73, s85, 7
    s_add_u32 s74, s73, s94
    s_lshr_b32 s74, s74, 1
    s_lshl_b32 s74, s74, 10
    s_add_u32 s74, s74, s72
    s_mul_i32 s75, s94, 6
    s_sub_u32 s75, 6, s75
    s_add_u32 s75, s75, s73
    s_lshr_b32 s75, s75, 1
    s_lshl_b32 s75, s75, 10
    s_add_u32 s75, s75, s72
    s_lshl_b32 s76, s94, 9
    s_add_u32 s75, s75, s76
    v_add_u32 v12, 57344, v5
    v_lshlrev_b32 v13, 3, v1
    v_add_u32 v9, 57344, v13
    s_waitcnt lgkmcnt(0)
    s_barrier
    ds_read_b64 v[64:65], v11 offset:1024
    ds_read_b64 v[66:67], v11 offset:1152
    ds_read_b128 v[80:83], v10 offset:256
    ds_read_b128 v[84:87], v10 offset:320
    ds_read_b128 v[88:91], v10 offset:384
    s_waitcnt lgkmcnt(3)
    v_mul_f32 v64, 0x3b000000, v64
    v_mul_f32 v65, 0x3b000000, v65
    v_fma_f32 v65, -v64, v64, v65
    v_max_f32 v65, 0, v65
    v_cvt_pk_bf16_f32 v64, v64, v65
    v_lshlrev_b32 v70, 16, v64
    v_lshlrev_b32 v71, 16, v64
    v_and_b32 v65, 0xffff0000, v64
    v_add_f32 v65, 0x3727c5ac, v65
    v_cvt_pk_bf16_f32 v65, v65, v65
    v_and_b32 v65, 0xffff0000, v65
    v_sqrt_f32 v65, v65
    v_mul_f32 v66, 0x3b000000, v66
    v_mul_f32 v67, 0x3b000000, v67
    v_fma_f32 v67, -v66, v66, v67
    v_max_f32 v67, 0, v67
    v_cvt_pk_bf16_f32 v66, v66, v67
    v_lshlrev_b32 v74, 16, v66
    v_lshlrev_b32 v75, 16, v66
    v_and_b32 v67, 0xffff0000, v66
    v_add_f32 v67, 0x3727c5ac, v67
    v_cvt_pk_bf16_f32 v67, v67, v67
    v_and_b32 v67, 0xffff0000, v67
    v_sqrt_f32 v67, v67
    v_cvt_pk_bf16_f32 v65, v65, v65
    v_and_b32 v65, 0xffff0000, v65
    v_rcp_f32 v68, v65
    v_rcp_f32 v69, v65
    v_cvt_pk_bf16_f32 v67, v67, v67
    v_and_b32 v67, 0xffff0000, v67
    v_rcp_f32 v72, v67
    v_rcp_f32 v73, v67
    s_waitcnt lgkmcnt(0)
    v_mul_f32 v128, 0xbfb8aa3b, v68
    v_mul_f32 v129, 0xbfb8aa3b, v68
    v_mul_f32 v130, 0xbfb8aa3b, v72
    v_mul_f32 v131, 0xbfb8aa3b, v72
    v_mov_b32 v132, 1.0
    v_mov_b32 v133, 1.0
    v_pk_fma_f32 v[16:17], v[80:81], v[70:71], v[16:17] neg_lo:[0,1,0] neg_hi:[0,1,0]
    v_pk_fma_f32 v[18:19], v[82:83], v[70:71], v[18:19] neg_lo:[0,1,0] neg_hi:[0,1,0]
    v_pk_fma_f32 v[20:21], v[80:81], v[74:75], v[20:21] neg_lo:[0,1,0] neg_hi:[0,1,0]
    v_pk_fma_f32 v[22:23], v[82:83], v[74:75], v[22:23] neg_lo:[0,1,0] neg_hi:[0,1,0]
    v_pk_fma_f32 v[24:25], v[84:85], v[70:71], v[24:25] neg_lo:[0,1,0] neg_hi:[0,1,0]
    v_pk_fma_f32 v[26:27], v[86:87], v[70:71], v[26:27] neg_lo:[0,1,0] neg_hi:[0,1,0]
    v_pk_fma_f32 v[28:29], v[84:85], v[74:75], v[28:29] neg_lo:[0,1,0] neg_hi:[0,1,0]
    v_pk_fma_f32 v[30:31], v[86:87], v[74:75], v[30:31] neg_lo:[0,1,0] neg_hi:[0,1,0]
    v_pk_mul_f32 v[96:97], v[16:17], v[128:129]
    v_pk_mul_f32 v[98:99], v[18:19], v[128:129]
    v_pk_mul_f32 v[100:101], v[20:21], v[130:131]
    v_pk_mul_f32 v[102:103], v[22:23], v[130:131]
    v_pk_mul_f32 v[104:105], v[24:25], v[128:129]
    v_pk_mul_f32 v[106:107], v[26:27], v[128:129]
    v_pk_mul_f32 v[108:109], v[28:29], v[130:131]
    v_pk_mul_f32 v[110:111], v[30:31], v[130:131]
    v_exp_f32 v96, v96
    v_exp_f32 v97, v97
    v_pk_mul_f32 v[16:17], v[16:17], v[68:69]
    v_exp_f32 v98, v98
    v_exp_f32 v99, v99
    v_pk_mul_f32 v[18:19], v[18:19], v[68:69]
    v_exp_f32 v100, v100
    v_exp_f32 v101, v101
    v_pk_mul_f32 v[20:21], v[20:21], v[72:73]
    v_exp_f32 v102, v102
    v_exp_f32 v103, v103
    v_pk_mul_f32 v[22:23], v[22:23], v[72:73]
    v_exp_f32 v104, v104
    v_exp_f32 v105, v105
    v_pk_mul_f32 v[24:25], v[24:25], v[68:69]
    v_exp_f32 v106, v106
    v_exp_f32 v107, v107
    v_pk_mul_f32 v[26:27], v[26:27], v[68:69]
    v_exp_f32 v108, v108
    v_exp_f32 v109, v109
    v_pk_mul_f32 v[28:29], v[28:29], v[72:73]
    v_exp_f32 v110, v110
    v_exp_f32 v111, v111
    v_pk_mul_f32 v[30:31], v[30:31], v[72:73]
    v_pk_add_f32 v[96:97], v[96:97], v[132:133]
    v_pk_add_f32 v[98:99], v[98:99], v[132:133]
    v_pk_add_f32 v[100:101], v[100:101], v[132:133]
    v_pk_add_f32 v[102:103], v[102:103], v[132:133]
    v_pk_add_f32 v[104:105], v[104:105], v[132:133]
    v_pk_add_f32 v[106:107], v[106:107], v[132:133]
    v_pk_add_f32 v[108:109], v[108:109], v[132:133]
    v_pk_add_f32 v[110:111], v[110:111], v[132:133]
    v_rcp_f32 v96, v96
    v_rcp_f32 v97, v97
    v_rcp_f32 v98, v98
    v_rcp_f32 v99, v99
    v_rcp_f32 v100, v100
    v_rcp_f32 v101, v101
    v_rcp_f32 v102, v102
    v_rcp_f32 v103, v103
    v_rcp_f32 v104, v104
    v_rcp_f32 v105, v105
    v_rcp_f32 v106, v106
    v_rcp_f32 v107, v107
    v_rcp_f32 v108, v108
    v_rcp_f32 v109, v109
    v_rcp_f32 v110, v110
    v_rcp_f32 v111, v111
    s_nop 0
    v_pk_mul_f32 v[16:17], v[16:17], v[96:97]
    v_pk_mul_f32 v[18:19], v[18:19], v[98:99]
    v_pk_mul_f32 v[20:21], v[20:21], v[100:101]
    v_pk_mul_f32 v[22:23], v[22:23], v[102:103]
    v_pk_mul_f32 v[24:25], v[24:25], v[104:105]
    v_pk_mul_f32 v[26:27], v[26:27], v[106:107]
    v_pk_mul_f32 v[28:29], v[28:29], v[108:109]
    v_pk_mul_f32 v[30:31], v[30:31], v[110:111]
    v_cvt_pk_bf16_f32 v96, v16, v17
    v_cvt_pk_bf16_f32 v97, v18, v19
    v_cvt_pk_bf16_f32 v98, v24, v25
    v_cvt_pk_bf16_f32 v99, v26, v27
    buffer_store_dwordx4 v[96:99], v5, s[68:71], s74 offen offset:2048 sc1
    v_cvt_pk_bf16_f32 v100, v20, v21
    v_cvt_pk_bf16_f32 v101, v22, v23
    v_cvt_pk_bf16_f32 v102, v28, v29
    v_cvt_pk_bf16_f32 v103, v30, v31
    buffer_store_dwordx4 v[100:103], v12, s[68:71], s74 offen offset:2048 sc1
    v_pk_fma_f32 v[32:33], v[88:89], v[70:71], v[32:33] neg_lo:[0,1,0] neg_hi:[0,1,0]
    v_pk_fma_f32 v[34:35], v[90:91], v[70:71], v[34:35] neg_lo:[0,1,0] neg_hi:[0,1,0]
    v_pk_fma_f32 v[36:37], v[88:89], v[74:75], v[36:37] neg_lo:[0,1,0] neg_hi:[0,1,0]
    v_pk_fma_f32 v[38:39], v[90:91], v[74:75], v[38:39] neg_lo:[0,1,0] neg_hi:[0,1,0]
    v_pk_mul_f32 v[112:113], v[32:33], v[128:129]
    v_pk_mul_f32 v[114:115], v[34:35], v[128:129]
    v_pk_mul_f32 v[116:117], v[36:37], v[130:131]
    v_pk_mul_f32 v[118:119], v[38:39], v[130:131]
    v_exp_f32 v112, v112
    v_exp_f32 v113, v113
    v_pk_mul_f32 v[32:33], v[32:33], v[68:69]
    v_exp_f32 v114, v114
    v_exp_f32 v115, v115
    v_pk_mul_f32 v[34:35], v[34:35], v[68:69]
    v_exp_f32 v116, v116
    v_exp_f32 v117, v117
    v_pk_mul_f32 v[36:37], v[36:37], v[72:73]
    v_exp_f32 v118, v118
    v_exp_f32 v119, v119
    v_pk_mul_f32 v[38:39], v[38:39], v[72:73]
    v_pk_add_f32 v[112:113], v[112:113], v[132:133]
    v_pk_add_f32 v[114:115], v[114:115], v[132:133]
    v_pk_add_f32 v[116:117], v[116:117], v[132:133]
    v_pk_add_f32 v[118:119], v[118:119], v[132:133]
    v_rcp_f32 v112, v112
    v_rcp_f32 v113, v113
    v_rcp_f32 v114, v114
    v_rcp_f32 v115, v115
    v_rcp_f32 v116, v116
    v_rcp_f32 v117, v117
    v_rcp_f32 v118, v118
    v_rcp_f32 v119, v119
    s_nop 0
    v_pk_mul_f32 v[32:33], v[32:33], v[112:113]
    v_pk_mul_f32 v[34:35], v[34:35], v[114:115]
    v_pk_mul_f32 v[36:37], v[36:37], v[116:117]
    v_pk_mul_f32 v[38:39], v[38:39], v[118:119]
    v_cvt_pk_bf16_f32 v112, v32, v33
    v_cvt_pk_bf16_f32 v113, v34, v35
    buffer_store_dwordx2 v[112:113], v13, s[68:71], s75 offen sc1
    v_cvt_pk_bf16_f32 v116, v36, v37
    v_cvt_pk_bf16_f32 v117, v38, v39
    buffer_store_dwordx2 v[116:117], v9, s[68:71], s75 offen sc1
L_g1_done:
    s_lshl_b32 s73, s84, 1
    s_lshr_b32 s72, s79, 1
    s_add_u32 s73, s73, s72
    s_lshl_b32 s73, s73, 4
    s_add_u32 s73, s73, s85
    s_lshl_b32 s73, s73, 2
    s_and_b32 s72, s79, 1
    s_lshl_b32 s72, s72, 1
    s_add_u32 s73, s73, s72
    s_add_u32 s73, s73, s78
    s_lshl_b32 s73, s73, 7
    s_add_u32 s73, s73, 21495808
    s_lshl_b32 s90, s84, 1
    s_add_u32 s90, s90, s94
    s_lshl_b32 s89, s90, 13
    s_add_u32 s89, s89, 21495808
    s_lshl_b32 s90, s90, 2
    s_mul_i32 s91, s86, 14
    s_add_u32 s91, s91, s87
    s_lshl_b32 s91, s91, 10
    s_add_u32 s91, s91, 12582912
    s_add_u32 s72, s86, 0
    s_and_b32 s72, s72, 3
    s_add_u32 s72, s72, s90
    s_mul_i32 s72, s72, 57344
    s_add_u32 s40, s72, s91
    s_add_u32 s72, s86, 1
    s_and_b32 s72, s72, 3
    s_add_u32 s72, s72, s90
    s_mul_i32 s72, s72, 57344
    s_add_u32 s41, s72, s91
    s_add_u32 s72, s86, 2
    s_and_b32 s72, s72, 3
    s_add_u32 s72, s72, s90
    s_mul_i32 s72, s72, 57344
    s_add_u32 s42, s72, s91
    s_add_u32 s72, s86, 3
    s_and_b32 s72, s72, 3
    s_add_u32 s72, s72, s90
    s_mul_i32 s72, s72, 57344
    s_add_u32 s43, s72, s91
    s_lshl_b32 s92, s86, 13
    s_lshl_b32 s72, s87, 12
    s_add_u32 s93, s92, s72
    v_add_u32 v10, s92, v5
    s_add_u32 s90, s90, s86
    s_lshr_b32 s95, s90, 1
    s_lshl_b32 s95, s95, 15
    s_and_b32 s72, s90, 1
    s_lshl_b32 s72, s72, 5
    s_add_u32 s95, s95, s72
    s_lshr_b32 s72, s85, 1
    s_lshl_b32 s72, s72, 1
    s_add_u32 s72, s72, s87
    s_lshl_b32 s72, s72, 11
    s_add_u32 s95, s95, s72
    s_add_u32 s95, s95, 6291456
    v_lshlrev_b32 v11, 9, v3
    v_lshl_add_u32 v11, v2, 1, v11
    v_add_u32 v12, 65536, v10
    v_lshlrev_b32 v186, 3, v1
    v_add_u32 v186, s92, v186
    v_add_u32 v187, 65536, v186
    v_add_u32 v188, 0x20000, v186
    s_waitcnt vmcnt(0)
    v_add_u32 v13, 0x20000, v10
    v_mov_b32 v4, 0
    s_mov_b64 exec, 1
    buffer_store_dwordx2 v[6:7], v4, s[68:71], s73 offen sc1
    s_mov_b64 exec, -1
    buffer_load_short_d16 v128, v11, s[68:71], s95 offen offset:0 sc1
    buffer_load_short_d16_hi v132, v11, s[68:71], s95 offen offset:64 sc1
    buffer_load_short_d16 v129, v11, s[68:71], s95 offen offset:128 sc1
    buffer_load_short_d16_hi v133, v11, s[68:71], s95 offen offset:192 sc1
    buffer_load_short_d16 v130, v11, s[68:71], s95 offen offset:256 sc1
    buffer_load_short_d16_hi v134, v11, s[68:71], s95 offen offset:320 sc1
    buffer_load_short_d16 v131, v11, s[68:71], s95 offen offset:384 sc1
    buffer_load_short_d16_hi v135, v11, s[68:71], s95 offen offset:448 sc1
    v_mov_b32 v16, 0
    v_mov_b32 v17, 0
    v_mov_b32 v18, 0
    v_mov_b32 v19, 0
    v_mov_b32 v20, 0
    v_mov_b32 v21, 0
    v_mov_b32 v22, 0
    v_mov_b32 v23, 0
    v_mov_b32 v24, 0
    v_mov_b32 v25, 0
    v_mov_b32 v26, 0
    v_mov_b32 v27, 0
    v_mov_b32 v28, 0
    v_mov_b32 v29, 0
    v_mov_b32 v30, 0
    v_mov_b32 v31, 0
    v_mov_b32 v32, 0
    v_mov_b32 v33, 0
    v_mov_b32 v34, 0
    v_mov_b32 v35, 0
    v_mov_b32 v36, 0
    v_mov_b32 v37, 0
    v_mov_b32 v38, 0
    v_mov_b32 v39, 0
    v_mov_b32 v40, 0
    v_mov_b32 v41, 0
    v_mov_b32 v42, 0
    v_mov_b32 v43, 0
    v_mov_b32 v44, 0
    v_mov_b32 v45, 0
    v_mov_b32 v46, 0
    v_mov_b32 v47, 0
    s_cmp_lg_u32 s28, 7
    s_cbranch_scc1 Lnp3_59
    s_mov_b64 s[4:5], -1
    s_mov_b32 s72, 40000
Lpn_60:
    s_mov_b64 exec, s[4:5]
    s_add_u32 s77, s89, 0
    s_cbranch_execz Lsk_63
    buffer_load_dwordx2 v[184:185], v14, s[68:71], s77 offen sc1
Lsk_63:
    s_mov_b64 exec, -1
Lpnc_62:
    s_waitcnt vmcnt(0)
    v_cmp_ne_u64 vcc, v[184:185], v[6:7]
    s_and_b64 s[4:5], s[4:5], vcc
    s_mov_b64 s[10:11], s[4:5]
    s_sub_u32 s72, s72, 1
    s_cmp_eq_u32 s72, 0
    s_cbranch_scc1 Lpnd_61
    s_cmp_eq_u64 s[10:11], 0
    s_cbranch_scc1 Lpnd_61
    s_branch Lpn_60
Lpnd_61:
Lnp3_59:
    s_barrier
    s_add_u32 m0, s93, 0
    s_add_u32 s72, s40, 0
    buffer_load_dwordx4 v5, s[68:71], s72 offen sc1 lds
    s_add_u32 m0, s93, 1024
    s_add_u32 s72, s41, 0
    buffer_load_dwordx4 v5, s[68:71], s72 offen sc1 lds
    s_add_u32 m0, s93, 2048
    s_add_u32 s72, s42, 0
    buffer_load_dwordx4 v5, s[68:71], s72 offen sc1 lds
    s_add_u32 m0, s93, 3072
    s_add_u32 s72, s43, 0
    buffer_load_dwordx4 v5, s[68:71], s72 offen sc1 lds
    s_add_u32 m0, s93, 32768
    s_add_u32 s72, s40, 2048
    buffer_load_dwordx4 v5, s[68:71], s72 offen sc1 lds
    s_add_u32 m0, s93, 33792
    s_add_u32 s72, s41, 2048
    buffer_load_dwordx4 v5, s[68:71], s72 offen sc1 lds
    s_add_u32 m0, s93, 34816
    s_add_u32 s72, s42, 2048
    buffer_load_dwordx4 v5, s[68:71], s72 offen sc1 lds
    s_add_u32 m0, s93, 35840
    s_add_u32 s72, s43, 2048
    buffer_load_dwordx4 v5, s[68:71], s72 offen sc1 lds
    s_add_u32 m0, s93, 65536
    s_add_u32 s72, s40, 4096
    buffer_load_dwordx4 v5, s[68:71], s72 offen sc1 lds
    s_add_u32 m0, s93, 66560
    s_add_u32 s72, s41, 4096
    buffer_load_dwordx4 v5, s[68:71], s72 offen sc1 lds
    s_add_u32 m0, s93, 67584
    s_add_u32 s72, s42, 4096
    buffer_load_dwordx4 v5, s[68:71], s72 offen sc1 lds
    s_add_u32 m0, s93, 68608
    s_add_u32 s72, s43, 4096
    buffer_load_dwordx4 v5, s[68:71], s72 offen sc1 lds
    s_add_u32 m0, s93, 98304
    s_add_u32 s72, s40, 6144
    buffer_load_dwordx4 v5, s[68:71], s72 offen sc1 lds
    s_add_u32 m0, s93, 99328
    s_add_u32 s72, s41, 6144
    buffer_load_dwordx4 v5, s[68:71], s72 offen sc1 lds
    s_add_u32 m0, s93, 100352
    s_add_u32 s72, s42, 6144
    buffer_load_dwordx4 v5, s[68:71], s72 offen sc1 lds
    s_add_u32 m0, s93, 101376
    s_add_u32 s72, s43, 6144
    buffer_load_dwordx4 v5, s[68:71], s72 offen sc1 lds
    s_add_u32 m0, s93, 131072
    s_add_u32 s72, s40, 8192
    buffer_load_dwordx4 v5, s[68:71], s72 offen sc1 lds
    s_add_u32 m0, s93, 132096
    s_add_u32 s72, s41, 8192
    buffer_load_dwordx4 v5, s[68:71], s72 offen sc1 lds
    s_add_u32 m0, s93, 133120
    s_add_u32 s72, s42, 8192
    buffer_load_dwordx4 v5, s[68:71], s72 offen sc1 lds
    s_add_u32 m0, s93, 134144
    s_add_u32 s72, s43, 8192
    buffer_load_dwordx4 v5, s[68:71], s72 offen sc1 lds
    s_waitcnt vmcnt(16)
    s_barrier
    ds_read_b128 v[64:67], v10 offset:0
    ds_read_b128 v[68:71], v10 offset:1024
    ds_read_b128 v[72:75], v10 offset:2048
    ds_read_b128 v[76:79], v10 offset:3072
    ds_read_b128 v[80:83], v10 offset:4096
    ds_read_b128 v[84:87], v10 offset:5120
    ds_read_b128 v[88:91], v10 offset:6144
    ds_read_b128 v[92:95], v10 offset:7168
    s_waitcnt lgkmcnt(7)
    v_mfma_f32_16x16x32_bf16 v[16:19], v[192:195], v[64:67], v[16:19]
    v_mfma_f32_16x16x32_bf16 v[20:23], v[196:199], v[64:67], v[20:23]
    s_waitcnt lgkmcnt(6)
    v_mfma_f32_16x16x32_bf16 v[24:27], v[192:195], v[68:71], v[24:27]
    v_mfma_f32_16x16x32_bf16 v[28:31], v[196:199], v[68:71], v[28:31]
    s_waitcnt lgkmcnt(5)
    v_mfma_f32_16x16x32_bf16 v[32:35], v[192:195], v[72:75], v[32:35]
    v_mfma_f32_16x16x32_bf16 v[36:39], v[196:199], v[72:75], v[36:39]
    s_waitcnt lgkmcnt(4)
    v_mfma_f32_16x16x32_bf16 v[40:43], v[192:195], v[76:79], v[40:43]
    v_mfma_f32_16x16x32_bf16 v[44:47], v[196:199], v[76:79], v[44:47]
    s_waitcnt lgkmcnt(3)
    v_mfma_f32_16x16x32_bf16 v[16:19], v[200:203], v[80:83], v[16:19]
    v_mfma_f32_16x16x32_bf16 v[20:23], v[204:207], v[80:83], v[20:23]
    s_waitcnt lgkmcnt(2)
    v_mfma_f32_16x16x32_bf16 v[24:27], v[200:203], v[84:87], v[24:27]
    v_mfma_f32_16x16x32_bf16 v[28:31], v[204:207], v[84:87], v[28:31]
    s_waitcnt lgkmcnt(1)
    v_mfma_f32_16x16x32_bf16 v[32:35], v[200:203], v[88:91], v[32:35]
    v_mfma_f32_16x16x32_bf16 v[36:39], v[204:207], v[88:91], v[36:39]
    s_waitcnt lgkmcnt(0)
    v_mfma_f32_16x16x32_bf16 v[40:43], v[200:203], v[92:95], v[40:43]
    v_mfma_f32_16x16x32_bf16 v[44:47], v[204:207], v[92:95], v[44:47]
    s_waitcnt vmcnt(12)
    s_barrier
    s_add_u32 m0, s93, 0
    s_add_u32 s72, s40, 10240
    buffer_load_dwordx4 v5, s[68:71], s72 offen sc1 lds
    s_add_u32 m0, s93, 1024
    s_add_u32 s72, s41, 10240
    buffer_load_dwordx4 v5, s[68:71], s72 offen sc1 lds
    s_add_u32 m0, s93, 2048
    s_add_u32 s72, s42, 10240
    buffer_load_dwordx4 v5, s[68:71], s72 offen sc1 lds
    s_add_u32 m0, s93, 3072
    s_add_u32 s72, s43, 10240
    buffer_load_dwordx4 v5, s[68:71], s72 offen sc1 lds
    ds_read_b128 v[96:99], v10 offset:32768
    ds_read_b128 v[100:103], v10 offset:33792
    ds_read_b128 v[104:107], v10 offset:34816
    ds_read_b128 v[108:111], v10 offset:35840
    ds_read_b64 v[112:113], v186 offset:36864
    ds_read_b64 v[114:115], v186 offset:37376
    ds_read_b64 v[116:117], v186 offset:37888
    ds_read_b64 v[118:119], v186 offset:38400
    ds_read_b64 v[120:121], v186 offset:38912
    ds_read_b64 v[122:123], v186 offset:39424
    ds_read_b64 v[124:125], v186 offset:39936
    ds_read_b64 v[126:127], v186 offset:40448
    s_waitcnt lgkmcnt(11)
    v_mfma_f32_16x16x32_bf16 v[16:19], v[208:211], v[96:99], v[16:19]
    v_mfma_f32_16x16x32_bf16 v[20:23], v[212:215], v[96:99], v[20:23]
    s_waitcnt lgkmcnt(10)
    v_mfma_f32_16x16x32_bf16 v[24:27], v[208:211], v[100:103], v[24:27]
    v_mfma_f32_16x16x32_bf16 v[28:31], v[212:215], v[100:103], v[28:31]
    s_waitcnt lgkmcnt(9)
    v_mfma_f32_16x16x32_bf16 v[32:35], v[208:211], v[104:107], v[32:35]
    v_mfma_f32_16x16x32_bf16 v[36:39], v[212:215], v[104:107], v[36:39]
    s_waitcnt lgkmcnt(8)
    v_mfma_f32_16x16x32_bf16 v[40:43], v[208:211], v[108:111], v[40:43]
    v_mfma_f32_16x16x32_bf16 v[44:47], v[212:215], v[108:111], v[44:47]
    s_waitcnt lgkmcnt(6)
    v_mfma_f32_16x16x32_bf16 v[16:19], v[216:219], v[112:115], v[16:19]
    v_mfma_f32_16x16x32_bf16 v[20:23], v[220:223], v[112:115], v[20:23]
    s_waitcnt lgkmcnt(4)
    v_mfma_f32_16x16x32_bf16 v[24:27], v[216:219], v[116:119], v[24:27]
    v_mfma_f32_16x16x32_bf16 v[28:31], v[220:223], v[116:119], v[28:31]
    s_waitcnt lgkmcnt(2)
    v_mfma_f32_16x16x32_bf16 v[32:35], v[216:219], v[120:123], v[32:35]
    v_mfma_f32_16x16x32_bf16 v[36:39], v[220:223], v[120:123], v[36:39]
    s_waitcnt lgkmcnt(0)
    v_mfma_f32_16x16x32_bf16 v[40:43], v[216:219], v[124:127], v[40:43]
    v_mfma_f32_16x16x32_bf16 v[44:47], v[220:223], v[124:127], v[44:47]
    s_waitcnt vmcnt(12)
    s_barrier
    s_add_u32 m0, s93, 32768
    s_add_u32 s72, s40, 12288
    buffer_load_dwordx4 v5, s[68:71], s72 offen sc1 lds
    s_add_u32 m0, s93, 33792
    s_add_u32 s72, s41, 12288
    buffer_load_dwordx4 v5, s[68:71], s72 offen sc1 lds
    s_add_u32 m0, s93, 34816
    s_add_u32 s72, s42, 12288
    buffer_load_dwordx4 v5, s[68:71], s72 offen sc1 lds
    s_add_u32 m0, s93, 35840
    s_add_u32 s72, s43, 12288
    buffer_load_dwordx4 v5, s[68:71], s72 offen sc1 lds
    ds_read_b128 v[64:67], v12 offset:0
    ds_read_b128 v[68:71], v12 offset:1024
    ds_read_b128 v[72:75], v12 offset:2048
    ds_read_b128 v[76:79], v12 offset:3072
    ds_read_b128 v[80:83], v12 offset:4096
    ds_read_b128 v[84:87], v12 offset:5120
    ds_read_b128 v[88:91], v12 offset:6144
    ds_read_b128 v[92:95], v12 offset:7168
    s_waitcnt lgkmcnt(7)
    v_mfma_f32_16x16x32_bf16 v[16:19], v[224:227], v[64:67], v[16:19]
    v_mfma_f32_16x16x32_bf16 v[20:23], v[228:231], v[64:67], v[20:23]
    s_waitcnt lgkmcnt(6)
    v_mfma_f32_16x16x32_bf16 v[24:27], v[224:227], v[68:71], v[24:27]
    v_mfma_f32_16x16x32_bf16 v[28:31], v[228:231], v[68:71], v[28:31]
    s_waitcnt lgkmcnt(5)
    v_mfma_f32_16x16x32_bf16 v[32:35], v[224:227], v[72:75], v[32:35]
    v_mfma_f32_16x16x32_bf16 v[36:39], v[228:231], v[72:75], v[36:39]
    s_waitcnt lgkmcnt(4)
    v_mfma_f32_16x16x32_bf16 v[40:43], v[224:227], v[76:79], v[40:43]
    v_mfma_f32_16x16x32_bf16 v[44:47], v[228:231], v[76:79], v[44:47]
    s_waitcnt lgkmcnt(3)
    v_mfma_f32_16x16x32_bf16 v[16:19], v[232:235], v[80:83], v[16:19]
    v_mfma_f32_16x16x32_bf16 v[20:23], v[236:239], v[80:83], v[20:23]
    s_waitcnt lgkmcnt(2)
    v_mfma_f32_16x16x32_bf16 v[24:27], v[232:235], v[84:87], v[24:27]
    v_mfma_f32_16x16x32_bf16 v[28:31], v[236:239], v[84:87], v[28:31]
    s_waitcnt lgkmcnt(1)
    v_mfma_f32_16x16x32_bf16 v[32:35], v[232:235], v[88:91], v[32:35]
    v_mfma_f32_16x16x32_bf16 v[36:39], v[236:239], v[88:91], v[36:39]
    s_waitcnt lgkmcnt(0)
    v_mfma_f32_16x16x32_bf16 v[40:43], v[232:235], v[92:95], v[40:43]
    v_mfma_f32_16x16x32_bf16 v[44:47], v[236:239], v[92:95], v[44:47]
    s_waitcnt vmcnt(12)
    s_barrier
    ds_read_b128 v[96:99], v12 offset:32768
    ds_read_b128 v[100:103], v12 offset:33792
    ds_read_b128 v[104:107], v12 offset:34816
    ds_read_b128 v[108:111], v12 offset:35840
    ds_read_b128 v[112:115], v12 offset:36864
    ds_read_b128 v[116:119], v12 offset:37888
    ds_read_b128 v[120:123], v12 offset:38912
    ds_read_b128 v[124:127], v12 offset:39936
    s_waitcnt lgkmcnt(7)
    v_mfma_f32_16x16x32_bf16 v[16:19], v[240:243], v[96:99], v[16:19]
    v_mfma_f32_16x16x32_bf16 v[20:23], v[244:247], v[96:99], v[20:23]
    s_waitcnt lgkmcnt(6)
    v_mfma_f32_16x16x32_bf16 v[24:27], v[240:243], v[100:103], v[24:27]
    v_mfma_f32_16x16x32_bf16 v[28:31], v[244:247], v[100:103], v[28:31]
    s_waitcnt lgkmcnt(5)
    v_mfma_f32_16x16x32_bf16 v[32:35], v[240:243], v[104:107], v[32:35]
    v_mfma_f32_16x16x32_bf16 v[36:39], v[244:247], v[104:107], v[36:39]
    s_waitcnt lgkmcnt(4)
    v_mfma_f32_16x16x32_bf16 v[40:43], v[240:243], v[108:111], v[40:43]
    v_mfma_f32_16x16x32_bf16 v[44:47], v[244:247], v[108:111], v[44:47]
    s_waitcnt lgkmcnt(3)
    v_mfma_f32_16x16x32_bf16 v[16:19], v[248:251], v[112:115], v[16:19]
    v_mfma_f32_16x16x32_bf16 v[20:23], v[252:255], v[112:115], v[20:23]
    s_waitcnt lgkmcnt(2)
    v_mfma_f32_16x16x32_bf16 v[24:27], v[248:251], v[116:119], v[24:27]
    v_mfma_f32_16x16x32_bf16 v[28:31], v[252:255], v[116:119], v[28:31]
    s_waitcnt lgkmcnt(1)
    v_mfma_f32_16x16x32_bf16 v[32:35], v[248:251], v[120:123], v[32:35]
    v_mfma_f32_16x16x32_bf16 v[36:39], v[252:255], v[120:123], v[36:39]
    s_waitcnt lgkmcnt(0)
    v_mfma_f32_16x16x32_bf16 v[40:43], v[248:251], v[124:127], v[40:43]
    v_mfma_f32_16x16x32_bf16 v[44:47], v[252:255], v[124:127], v[44:47]
    s_waitcnt vmcnt(8)
    s_barrier
    ds_read_b128 v[64:67], v13 offset:0
    ds_read_b128 v[68:71], v13 offset:1024
    ds_read_b128 v[72:75], v13 offset:2048
    ds_read_b128 v[76:79], v13 offset:3072
    ds_read_b128 v[80:83], v13 offset:4096
    ds_read_b128 v[84:87], v13 offset:5120
    ds_read_b128 v[88:91], v13 offset:6144
    ds_read_b128 v[92:95], v13 offset:7168
    s_waitcnt lgkmcnt(7)
    v_mfma_f32_16x16x32_bf16 v[16:19], v[136:139], v[64:67], v[16:19]
    v_mfma_f32_16x16x32_bf16 v[20:23], v[140:143], v[64:67], v[20:23]
    s_waitcnt lgkmcnt(6)
    v_mfma_f32_16x16x32_bf16 v[24:27], v[136:139], v[68:71], v[24:27]
    v_mfma_f32_16x16x32_bf16 v[28:31], v[140:143], v[68:71], v[28:31]
    s_waitcnt lgkmcnt(5)
    v_mfma_f32_16x16x32_bf16 v[32:35], v[136:139], v[72:75], v[32:35]
    v_mfma_f32_16x16x32_bf16 v[36:39], v[140:143], v[72:75], v[36:39]
    s_waitcnt lgkmcnt(4)
    v_mfma_f32_16x16x32_bf16 v[40:43], v[136:139], v[76:79], v[40:43]
    v_mfma_f32_16x16x32_bf16 v[44:47], v[140:143], v[76:79], v[44:47]
    s_waitcnt lgkmcnt(3)
    v_mfma_f32_16x16x32_bf16 v[16:19], v[144:147], v[80:83], v[16:19]
    v_mfma_f32_16x16x32_bf16 v[20:23], v[148:151], v[80:83], v[20:23]
    s_waitcnt lgkmcnt(2)
    v_mfma_f32_16x16x32_bf16 v[24:27], v[144:147], v[84:87], v[24:27]
    v_mfma_f32_16x16x32_bf16 v[28:31], v[148:151], v[84:87], v[28:31]
    s_waitcnt lgkmcnt(1)
    v_mfma_f32_16x16x32_bf16 v[32:35], v[144:147], v[88:91], v[32:35]
    v_mfma_f32_16x16x32_bf16 v[36:39], v[148:151], v[88:91], v[36:39]
    s_waitcnt lgkmcnt(0)
    v_mfma_f32_16x16x32_bf16 v[40:43], v[144:147], v[92:95], v[40:43]
    v_mfma_f32_16x16x32_bf16 v[44:47], v[148:151], v[92:95], v[44:47]
    s_waitcnt vmcnt(4)
    s_barrier
    ds_read_b64 v[96:97], v186 offset:0
    ds_read_b64 v[98:99], v186 offset:512
    ds_read_b64 v[100:101], v186 offset:1024
    ds_read_b64 v[102:103], v186 offset:1536
    ds_read_b64 v[104:105], v186 offset:2048
    ds_read_b64 v[106:107], v186 offset:2560
    ds_read_b64 v[108:109], v186 offset:3072
    ds_read_b64 v[110:111], v186 offset:3584
    ds_read_b128 v[112:115], v10 offset:4096
    ds_read_b128 v[116:119], v10 offset:5120
    ds_read_b128 v[120:123], v10 offset:6144
    ds_read_b128 v[124:127], v10 offset:7168
    s_waitcnt lgkmcnt(10)
    v_mfma_f32_16x16x32_bf16 v[16:19], v[152:155], v[96:99], v[16:19]
    v_mfma_f32_16x16x32_bf16 v[20:23], v[156:159], v[96:99], v[20:23]
    s_waitcnt lgkmcnt(8)
    v_mfma_f32_16x16x32_bf16 v[24:27], v[152:155], v[100:103], v[24:27]
    v_mfma_f32_16x16x32_bf16 v[28:31], v[156:159], v[100:103], v[28:31]
    s_waitcnt lgkmcnt(6)
    v_mfma_f32_16x16x32_bf16 v[32:35], v[152:155], v[104:107], v[32:35]
    v_mfma_f32_16x16x32_bf16 v[36:39], v[156:159], v[104:107], v[36:39]
    s_waitcnt lgkmcnt(4)
    v_mfma_f32_16x16x32_bf16 v[40:43], v[152:155], v[108:111], v[40:43]
    v_mfma_f32_16x16x32_bf16 v[44:47], v[156:159], v[108:111], v[44:47]
    s_waitcnt lgkmcnt(3)
    v_mfma_f32_16x16x32_bf16 v[16:19], v[160:163], v[112:115], v[16:19]
    v_mfma_f32_16x16x32_bf16 v[20:23], v[164:167], v[112:115], v[20:23]
    s_waitcnt lgkmcnt(2)
    v_mfma_f32_16x16x32_bf16 v[24:27], v[160:163], v[116:119], v[24:27]
    v_mfma_f32_16x16x32_bf16 v[28:31], v[164:167], v[116:119], v[28:31]
    s_waitcnt lgkmcnt(1)
    v_mfma_f32_16x16x32_bf16 v[32:35], v[160:163], v[120:123], v[32:35]
    v_mfma_f32_16x16x32_bf16 v[36:39], v[164:167], v[120:123], v[36:39]
    s_waitcnt lgkmcnt(0)
    v_mfma_f32_16x16x32_bf16 v[40:43], v[160:163], v[124:127], v[40:43]
    v_mfma_f32_16x16x32_bf16 v[44:47], v[164:167], v[124:127], v[44:47]
    s_waitcnt vmcnt(0)
    s_barrier
    ds_read_b128 v[64:67], v10 offset:32768
    ds_read_b128 v[68:71], v10 offset:33792
    ds_read_b128 v[72:75], v10 offset:34816
    ds_read_b128 v[76:79], v10 offset:35840
    ds_read_b128 v[80:83], v10 offset:36864
    ds_read_b128 v[84:87], v10 offset:37888
    ds_read_b128 v[88:91], v10 offset:38912
    ds_read_b128 v[92:95], v10 offset:39936
    s_waitcnt lgkmcnt(7)
    v_mfma_f32_16x16x32_bf16 v[16:19], v[168:171], v[64:67], v[16:19]
    v_mfma_f32_16x16x32_bf16 v[20:23], v[172:175], v[64:67], v[20:23]
    s_waitcnt lgkmcnt(6)
    v_mfma_f32_16x16x32_bf16 v[24:27], v[168:171], v[68:71], v[24:27]
    v_mfma_f32_16x16x32_bf16 v[28:31], v[172:175], v[68:71], v[28:31]
    s_waitcnt lgkmcnt(5)
    v_mfma_f32_16x16x32_bf16 v[32:35], v[168:171], v[72:75], v[32:35]
    v_mfma_f32_16x16x32_bf16 v[36:39], v[172:175], v[72:75], v[36:39]
    s_waitcnt lgkmcnt(4)
    v_mfma_f32_16x16x32_bf16 v[40:43], v[168:171], v[76:79], v[40:43]
    v_mfma_f32_16x16x32_bf16 v[44:47], v[172:175], v[76:79], v[44:47]
    s_waitcnt lgkmcnt(3)
    v_mfma_f32_16x16x32_bf16 v[16:19], v[176:179], v[80:83], v[16:19]
    v_mfma_f32_16x16x32_bf16 v[20:23], v[180:183], v[80:83], v[20:23]
    s_waitcnt lgkmcnt(2)
    v_mfma_f32_16x16x32_bf16 v[24:27], v[176:179], v[84:87], v[24:27]
    v_mfma_f32_16x16x32_bf16 v[28:31], v[180:183], v[84:87], v[28:31]
    s_waitcnt lgkmcnt(1)
    v_mfma_f32_16x16x32_bf16 v[32:35], v[176:179], v[88:91], v[32:35]
    v_mfma_f32_16x16x32_bf16 v[36:39], v[180:183], v[88:91], v[36:39]
    s_waitcnt lgkmcnt(0)
    v_mfma_f32_16x16x32_bf16 v[40:43], v[176:179], v[92:95], v[40:43]
    v_mfma_f32_16x16x32_bf16 v[44:47], v[180:183], v[92:95], v[44:47]
    s_barrier
    s_add_u32 s72, s86, 1
    s_and_b32 s72, s72, 3
    s_lshl_b32 s73, s87, 2
    s_add_u32 s72, s72, s73
    s_mul_i32 s72, s72, 6144
    s_add_u32 s72, s72, 0
    v_add_u32 v11, s72, v5
    s_add_u32 s72, s86, 2
    s_and_b32 s72, s72, 3
    s_lshl_b32 s73, s87, 2
    s_add_u32 s72, s72, s73
    s_mul_i32 s72, s72, 6144
    s_add_u32 s72, s72, 2048
    v_add_u32 v12, s72, v5
    s_add_u32 s72, s86, 3
    s_and_b32 s72, s72, 3
    s_lshl_b32 s73, s87, 2
    s_add_u32 s72, s72, s73
    s_mul_i32 s72, s72, 6144
    s_add_u32 s72, s72, 4096
    v_add_u32 v13, s72, v5
    s_lshl_b32 s73, s87, 2
    s_add_u32 s72, s86, s73
    s_mul_i32 s72, s72, 6144
    v_add_u32 v10, s72, v5
    ds_write_b128 v11, v[24:27] offset:0
    ds_write_b128 v11, v[28:31] offset:1024
    ds_write_b128 v12, v[32:35] offset:0
    ds_write_b128 v12, v[36:39] offset:1024
    ds_write_b128 v13, v[40:43] offset:0
    ds_write_b128 v13, v[44:47] offset:1024
    s_lshl_b32 s72, s90, 14
    s_lshr_b32 s73, s85, 1
    s_lshl_b32 s73, s73, 7
    s_add_u32 s72, s72, s73
    s_lshl_b32 s73, s87, 6
    s_add_u32 s72, s72, s73
    v_lshlrev_b32 v9, 10, v2
    v_lshl_add_u32 v9, v3, 4, v9
    v_lshlrev_b32 v96, 16, v128
    v_and_b32 v100, 0xffff0000, v132
    v_lshlrev_b32 v97, 16, v129
    v_and_b32 v101, 0xffff0000, v133
    v_lshlrev_b32 v98, 16, v130
    v_and_b32 v102, 0xffff0000, v134
    v_lshlrev_b32 v99, 16, v131
    v_and_b32 v103, 0xffff0000, v135
    s_waitcnt lgkmcnt(0)
    s_barrier
    ds_read_b128 v[64:67], v10 offset:0
    ds_read_b128 v[68:71], v10 offset:1024
    ds_read_b128 v[72:75], v10 offset:2048
    ds_read_b128 v[76:79], v10 offset:3072
    ds_read_b128 v[80:83], v10 offset:4096
    ds_read_b128 v[84:87], v10 offset:5120
    v_pk_add_f32 v[16:17], v[16:17], v[96:97]
    v_pk_add_f32 v[18:19], v[18:19], v[98:99]
    v_pk_add_f32 v[20:21], v[20:21], v[100:101]
    v_pk_add_f32 v[22:23], v[22:23], v[102:103]
    s_waitcnt lgkmcnt(0)
    v_pk_add_f32 v[16:17], v[16:17], v[64:65]
    v_pk_add_f32 v[72:73], v[72:73], v[80:81]
    v_pk_add_f32 v[18:19], v[18:19], v[66:67]
    v_pk_add_f32 v[74:75], v[74:75], v[82:83]
    v_pk_add_f32 v[20:21], v[20:21], v[68:69]
    v_pk_add_f32 v[76:77], v[76:77], v[84:85]
    v_pk_add_f32 v[22:23], v[22:23], v[70:71]
    v_pk_add_f32 v[78:79], v[78:79], v[86:87]
    v_pk_add_f32 v[16:17], v[16:17], v[72:73]
    v_pk_add_f32 v[18:19], v[18:19], v[74:75]
    v_pk_add_f32 v[20:21], v[20:21], v[76:77]
    v_pk_add_f32 v[22:23], v[22:23], v[78:79]
    v_cvt_pk_bf16_f32 v104, v16, v20
    v_cvt_pk_bf16_f32 v105, v17, v21
    v_cvt_pk_bf16_f32 v106, v18, v22
    v_cvt_pk_bf16_f32 v107, v19, v23
    buffer_store_dwordx4 v[104:107], v9, s[60:63], s72 offen
L_fin:
L_end:
    s_endpgm
.section .rodata,"a"
.p2align 6
.amdhsa_kernel sequential_preLN__ssm_conv_h3__dense_activation_silu__prompt_kernel
  .amdhsa_next_free_vgpr 256
  .amdhsa_next_free_sgpr 102
  .amdhsa_accum_offset 256
  .amdhsa_group_segment_fixed_size 0
  .amdhsa_kernarg_size 96
  .amdhsa_user_sgpr_count 2
  .amdhsa_user_sgpr_kernarg_segment_ptr 1
  .amdhsa_system_sgpr_workgroup_id_x 1
.end_amdhsa_kernel
```
